```python
import torch

def _softmax(x, axis=-1):
    return torch.softmax(x, dim=axis)
def _gelu(x):
    return torch.nn.functional.gelu(x, approximate="tanh")
def _silu(x):
    return torch.nn.functional.silu(x)
def _sigmoid(x):
    return torch.sigmoid(x)
def _layernorm(x, axis=-1, eps=1e-5):
    m = x.mean(dim=axis, keepdim=True)
    v = x.var(dim=axis, keepdim=True, unbiased=False)
    return (x - m) / torch.sqrt(v + eps)
def _scatter_add(tgt, idx, src, axis=0):
    return tgt.clone().index_add_(axis, idx, src)
def _segment_sum(src, seg, n):
    out = torch.zeros((n,) + src.shape[1:], dtype=src.dtype)
    return out.index_add_(0, seg, src)
def _pad(x, pw):
    flat = tuple(v for pair in reversed(pw) for v in pair)
    return torch.nn.functional.pad(x, flat)

kernel_name = 'sequential_preLN__gqa_block_cached__glu_gated_bilinear__decode'

def setup_inputs():

    _w = (lambda a: (lambda t: t.to(torch.bfloat16) if t.is_floating_point() else t)(torch.as_tensor(a)))
    def _A_setup():
        B, Sq, D = 8, 1, 448
        Hq, Hkv, Sk, Dh = 16, 8, 8192, 256
        assert Hq % Hkv == 0, (Hq, Hkv)
        return {
            "x": _w((lambda *s: torch.randn(*s, dtype=torch.bfloat16) * 0.05)(B, Sq, D)),
            "k_cache": _w((lambda *s: torch.randn(*s, dtype=torch.bfloat16) * 1.6)(B, Hkv, Sk, Dh)),
            "v_cache": _w((lambda *s: torch.randn(*s, dtype=torch.bfloat16) * 0.8)(B, Hkv, Sk, Dh)),
            "wq": _w((lambda *s: torch.randn(*s, dtype=torch.bfloat16) * 1.6)(D, Hq * Dh) * (D ** -0.5)),
            "wo": _w((lambda *s: torch.randn(*s, dtype=torch.bfloat16) * 0.8)(Hq * Dh, D) * ((Hq * Dh) ** -0.5)),
        }
    _A_in = _A_setup()

    def _B_setup():
        B, S, D, F = 8, 1, 448, 1792
        return {
            "x": _w((lambda *s: torch.randn(*s, dtype=torch.bfloat16) * 0.05)(B, S, D)),
            "w_gate": _w((lambda *s: torch.randn(*s, dtype=torch.bfloat16) * 0.4)(D, F) * (D ** -0.5)),
            "w_up": _w((lambda *s: torch.randn(*s, dtype=torch.bfloat16) * 0.4)(D, F) * (D ** -0.5)),
            "w_down": _w((lambda *s: torch.randn(*s, dtype=torch.bfloat16) * 0.4)(F, D) * (F ** -0.5)),
        }
    _B_in = _B_setup()

    return {
        "A_x": _A_in["x"],
        "A_k_cache": _A_in["k_cache"],
        "A_v_cache": _A_in["v_cache"],
        "A_wq": _A_in["wq"],
        "A_wo": _A_in["wo"],
        "B_x": _B_in["x"],
        "B_w_gate": _B_in["w_gate"],
        "B_w_up": _B_in["w_up"],
        "B_w_down": _B_in["w_down"],
    }

def reference(A_x, A_k_cache, A_v_cache, A_wq, A_wo, B_x, B_w_gate, B_w_up, B_w_down):
    def _A_ref(x, k_cache, v_cache, wq, wo):
        B, Sq, D = x.shape
        Hq, Dh = 16, 256
        Hkv = k_cache.shape[1]
        rep = Hq // Hkv
        q = (lambda x, *d: x.permute(*d))((x @ wq).reshape(B, Sq, Hq, Dh), 0, 2, 1, 3)
        k = (lambda x, n, axis: torch.repeat_interleave(x, n, dim=axis))(k_cache, rep, axis=1)
        v = (lambda x, n, axis: torch.repeat_interleave(x, n, dim=axis))(v_cache, rep, axis=1)
        scores = torch.einsum("bhqd,bhkd->bhqk", q, k) * (Dh ** -0.5)
        p = _softmax(scores, axis=-1)
        o = torch.einsum("bhqk,bhkd->bhqd", p, v)
        return (lambda x, *d: x.permute(*d))(o, 0, 2, 1, 3).reshape(B, Sq, Hq * Dh) @ wo

    def _B_ref(x, w_gate, w_up, w_down):
        g = torch.einsum("bsd,df->bsf", x, w_gate)
        u = torch.einsum("bsd,df->bsf", x, w_up)
        h = g * u
        return torch.einsum("bsf,fd->bsd", h, w_down)

    x = A_x
    h = x + _A_ref(_layernorm(x, axis=-1), A_k_cache, A_v_cache, A_wq, A_wo)
    h2 = h + _B_ref(_layernorm(h, axis=-1), B_w_gate, B_w_up, B_w_down)
    return h2
```

```asm
; @launch grid=(256,1,1) block=(512,1,1) lds=152576
.amdgcn_target "amdgcn-amd-amdhsa--gfx950"
.text
.globl sequential_preLN__gqa_block_cached__glu_gated_bilinear__decode_kernel
.p2align 8
.type sequential_preLN__gqa_block_cached__glu_gated_bilinear__decode_kernel,@function
sequential_preLN__gqa_block_cached__glu_gated_bilinear__decode_kernel:
  s_cmp_ge_u32 s2, 256
  s_cbranch_scc1 sequential_preLN__gqa_block_cached__glu_gated_bilinear__decode_kernel_exit
  s_load_dwordx8 s[4:11], s[0:1], 0
  s_load_dwordx2 s[60:61], s[0:1], 32
  s_load_dwordx8 s[64:71], s[0:1], 48
  s_load_dwordx4 s[12:15], s[0:1], 80
  v_mov_b32 v14, 0
  v_mov_b32 v15, 0
  ds_write_b64 v14, v[14:15] offset:1152
  v_lshrrev_b32 v1, 6, v0
  s_nop 0
  v_readfirstlane_b32 s3, v1
  v_and_b32 v1, 63, v0
  v_and_b32 v2, 15, v1
  v_lshrrev_b32 v3, 4, v1
  s_and_b32 s94, s2, 7
  s_lshr_b32 s95, s2, 3
  s_and_b32 s47, s95, 3
  s_lshr_b32 s46, s95, 2
  s_and_b32 s43, s47, 1
  s_lshr_b32 s48, s47, 1
  s_lshl_b32 s48, s48, 2
  s_add_u32 s43, s43, s48
  s_sub_u32 s43, s94, s43
  s_and_b32 s43, s43, 7
  s_lshl_b32 s48, s46, 3
  s_add_u32 s48, s48, s43
  s_lshl_b32 s96, s47, 6
  s_add_u32 s96, s96, s48
  s_lshl_b32 s97, s47, 3
  s_add_u32 s97, s97, s3
  s_mov_b32 s41, 0x05040100
  s_mov_b32 s42, 0x07060302
  s_mov_b32 s44, 0xffff0000
  s_mov_b32 s45, 0x3db8aa3b
  s_mov_b32 s80, 0x40000
  s_mov_b32 s72, 1
  s_mov_b32 s73, s96
  s_cmp_ge_u32 s96, 112
  s_cselect_b32 s72, 2, s72
  s_sub_u32 s51, s96, 112
  s_cselect_b32 s73, s73, s51
  s_cmp_ge_u32 s96, 112
  s_cselect_b32 s73, s51, s73
  s_sub_u32 s51, s96, 176
  s_cmp_ge_u32 s96, 176
  s_cselect_b32 s72, 3, s72
  s_cselect_b32 s73, s51, s73
  s_sub_u32 s51, s96, 204
  s_cmp_ge_u32 s96, 204
  s_cselect_b32 s72, 4, s72
  s_cselect_b32 s73, s51, s73
  s_cmp_ge_u32 s96, 218
  s_cselect_b32 s72, 0, s72
  v_lshrrev_b32 v4, 2, v2
  v_lshlrev_b32 v4, 9, v4
  v_and_b32 v7, 3, v2
  v_lshl_add_u32 v4, v7, 6, v4
  v_lshl_add_u32 v4, v3, 4, v4
  v_lshlrev_b32 v5, 9, v3
  v_lshl_add_u32 v5, v2, 4, v5
  s_lshl_b32 s49, s48, 22
  s_lshr_b32 s50, s48, 10
  s_lshl_b32 s98, s48, 8
  s_add_u32 s98, s98, 1245184
  s_waitcnt lgkmcnt(0)
  s_barrier
  s_add_u32 s52, s14, 1277952
  s_addc_u32 s53, s15, 0
  s_load_dwordx2 s[82:83], s[52:53], 0
  s_add_u32 s16, s6, s49
  s_addc_u32 s17, s7, s50
  s_mov_b32 s18, 0x400000
  s_mov_b32 s19, 0x00020000
  s_add_u32 s20, s8, s49
  s_addc_u32 s21, s9, s50
  s_mov_b32 s22, 0x400000
  s_mov_b32 s23, 0x00020000
  s_mov_b32 s32, s14
  s_mov_b32 s33, s15
  s_mov_b32 s34, 1867776
  s_mov_b32 s35, 0x00020000
  s_mov_b32 s24, s14
  s_mov_b32 s25, s15
  s_mov_b32 s26, 1867776
  s_mov_b32 s27, 0x00020000
  s_mov_b32 s85, 0
  s_mov_b32 s76, s12
  s_mov_b32 s77, s13
  s_mov_b32 s78, 256
  s_mov_b32 s79, 0x00020000
  s_mov_b32 s28, s4
  s_mov_b32 s29, s5
  s_mov_b32 s30, 7168
  s_mov_b32 s31, 0x00020000
  s_mov_b32 s59, 0x00020000
  s_mul_i32 s84, s48, 4
  s_mov_b32 s74, s10
  s_mov_b32 s75, s11
  s_add_u32 s8, s97, s84
  s_add_u32 s36, s8, 32
  s_and_b32 s8, s8, 255
  s_lshl_b32 s8, s8, 14
  s_add_u32 s9, s8, 4096
  s_add_u32 s10, s8, 8192
  s_add_u32 s11, s8, 12288
  s_and_b32 s36, s36, 255
  s_lshl_b32 s36, s36, 14
  s_add_u32 s37, s36, 4096
  s_add_u32 s38, s36, 8192
  s_add_u32 s39, s36, 12288
  s_lshl_b32 s89, s2, 3
  s_add_u32 s89, s89, s3
  s_lshl_b32 s89, s89, 7
  s_add_u32 s89, s89, 1310720
  s_mul_i32 s51, s3, 896
  v_lshlrev_b32 v7, 4, v1
  v_min_u32 v7, 880, v7
  s_cmp_lg_u32 s72, 2
  s_cselect_b32 s51, 0x10000, s51
  buffer_load_dwordx4 v[8:11], v7, s[28:31], s51 offen
  v_mov_b32 v13, 0
  v_mov_b32 v6, 0
  v_mov_b32 v24, 0
  s_cmp_lg_u32 s3, 0
  s_cbranch_scc1 sequential_preLN__gqa_block_cached__glu_gated_bilinear__decode_kernel_w17
  v_mov_b32 v18, -1
  v_mov_b32 v19, -1
  v_mov_b32 v20, -1
  v_mov_b32 v21, -1
  v_mov_b32 v28, 0
  v_mov_b32 v29, 0
  v_mov_b32 v30, 0
  v_mov_b32 v31, 0
  v_mov_b32 v12, 96
  v_lshlrev_b32 v7, 4, v1
  s_cmp_lg_u32 s47, 0
  s_cselect_b32 s51, 1867776, s98
  s_mov_b64 exec, 1
  buffer_store_dword v12, v13, s[32:35], s51 offen sc1
  s_mov_b64 exec, -1
  s_cmp_lg_u32 s72, 2
  s_cbranch_scc1 sequential_preLN__gqa_block_cached__glu_gated_bilinear__decode_kernel_w0_notq
  s_waitcnt vmcnt(1)
  s_waitcnt lgkmcnt(0)
  s_add_u32 s62, s82, 1
  s_addc_u32 s63, s83, 0
  s_lshr_b64 s[100:101], s[62:63], 16
  s_lshl_b32 s101, s62, 16
  v_lshlrev_b32 v32, 16, v8
  v_and_b32 v33, s44, v8
  v_lshlrev_b32 v34, 16, v9
  v_and_b32 v35, s44, v9
  v_lshlrev_b32 v36, 16, v10
  v_and_b32 v37, s44, v10
  v_lshlrev_b32 v38, 16, v11
  v_and_b32 v39, s44, v11
  v_readfirstlane_b32 s51, v32
  v_cmp_gt_u32 vcc, 56, v1
  s_nop 0
  v_subrev_f32 v40, s51, v32
  v_subrev_f32 v42, s51, v33
  v_mul_f32 v41, v40, v40
  v_add_f32 v40, v40, v42
  v_fmac_f32 v41, v42, v42
  v_subrev_f32 v42, s51, v34
  v_add_f32 v40, v40, v42
  v_fmac_f32 v41, v42, v42
  v_subrev_f32 v43, s51, v35
  v_add_f32 v40, v40, v43
  v_fmac_f32 v41, v43, v43
  v_subrev_f32 v42, s51, v36
  v_add_f32 v40, v40, v42
  v_fmac_f32 v41, v42, v42
  v_subrev_f32 v43, s51, v37
  v_add_f32 v40, v40, v43
  v_fmac_f32 v41, v43, v43
  v_subrev_f32 v42, s51, v38
  v_add_f32 v40, v40, v42
  v_fmac_f32 v41, v42, v42
  v_subrev_f32 v43, s51, v39
  v_add_f32 v40, v40, v43
  v_fmac_f32 v41, v43, v43
  v_cndmask_b32 v40, 0, v40, vcc
  v_cndmask_b32 v41, 0, v41, vcc
  s_nop 0
  v_add_f32_dpp v40, v40, v40 quad_perm:[1,0,3,2] row_mask:0xf bank_mask:0xf
  v_add_f32_dpp v41, v41, v41 quad_perm:[1,0,3,2] row_mask:0xf bank_mask:0xf
  s_nop 0
  v_add_f32_dpp v40, v40, v40 quad_perm:[2,3,0,1] row_mask:0xf bank_mask:0xf
  v_add_f32_dpp v41, v41, v41 quad_perm:[2,3,0,1] row_mask:0xf bank_mask:0xf
  s_nop 0
  v_add_f32_dpp v40, v40, v40 row_half_mirror row_mask:0xf bank_mask:0xf
  v_add_f32_dpp v41, v41, v41 row_half_mirror row_mask:0xf bank_mask:0xf
  s_nop 0
  v_add_f32_dpp v40, v40, v40 row_mirror row_mask:0xf bank_mask:0xf
  v_add_f32_dpp v41, v41, v41 row_mirror row_mask:0xf bank_mask:0xf
  v_mov_b32 v42, v40
  v_mov_b32 v43, v41
  s_nop 0
  v_permlane16_swap_b32 v40, v42
  v_permlane16_swap_b32 v41, v43
  v_add_f32 v40, v40, v42
  v_add_f32 v41, v41, v43
  v_mov_b32 v42, v40
  v_mov_b32 v43, v41
  s_nop 0
  v_permlane32_swap_b32 v40, v42
  v_permlane32_swap_b32 v41, v43
  v_add_f32 v40, v40, v42
  v_add_f32 v41, v41, v43
  v_mul_f32 v40, 0x3b124925, v40
  v_mul_f32 v41, 0x3b124925, v41
  v_fma_f32 v41, -v40, v40, v41
  v_max_f32 v41, 0, v41
  v_add_f32 v40, s51, v40
  v_cvt_pk_bf16_f32 v42, v40, v41
  v_lshlrev_b32 v40, 16, v42
  v_and_b32 v41, s44, v42
  v_add_f32 v41, 0x3727c5ac, v41
  v_cvt_pk_bf16_f32 v41, v41, v41
  v_lshlrev_b32 v41, 16, v41
  v_sqrt_f32 v41, v41
  v_sub_f32 v32, v32, v40
  v_sub_f32 v33, v33, v40
  v_sub_f32 v34, v34, v40
  v_sub_f32 v35, v35, v40
  v_sub_f32 v36, v36, v40
  v_sub_f32 v37, v37, v40
  v_sub_f32 v38, v38, v40
  v_sub_f32 v39, v39, v40
  v_cvt_pk_bf16_f32 v41, v41, v41
  v_lshlrev_b32 v41, 16, v41
  v_rcp_f32 v41, v41
  v_cvt_pk_bf16_f32 v42, v32, v33
  v_lshlrev_b32 v32, 16, v42
  v_and_b32 v33, s44, v42
  v_mul_f32 v32, v32, v41
  v_mul_f32 v33, v33, v41
  v_cvt_pk_bf16_f32 v8, v32, v33
  v_cvt_pk_bf16_f32 v42, v34, v35
  v_lshlrev_b32 v34, 16, v42
  v_and_b32 v35, s44, v42
  v_mul_f32 v34, v34, v41
  v_mul_f32 v35, v35, v41
  v_cvt_pk_bf16_f32 v9, v34, v35
  v_cvt_pk_bf16_f32 v42, v36, v37
  v_lshlrev_b32 v36, 16, v42
  v_and_b32 v37, s44, v42
  v_mul_f32 v36, v36, v41
  v_mul_f32 v37, v37, v41
  v_cvt_pk_bf16_f32 v10, v36, v37
  v_cvt_pk_bf16_f32 v42, v38, v39
  v_lshlrev_b32 v38, 16, v42
  v_and_b32 v39, s44, v42
  v_mul_f32 v38, v38, v41
  v_mul_f32 v39, v39, v41
  v_cvt_pk_bf16_f32 v11, v38, v39
  s_mul_i32 s51, s3, 1056
  v_lshl_add_u32 v12, v1, 4, s51
  ds_write_b128 v12, v[8:11] offset:1280
  v_mov_b32 v12, 1
  v_mov_b32 v13, 0
  s_waitcnt lgkmcnt(0)
  s_mov_b64 exec, 1
  ds_add_u32 v13, v12 offset:1152
  s_mov_b64 exec, -1
  v_and_b32 v6, 7, v2
  v_mul_u32_u24 v6, 1056, v6
  v_lshl_add_u32 v6, v3, 4, v6
  s_mul_i32 s51, s3, 14336
  s_add_u32 s51, s51, 29696
  v_lshl_add_u32 v7, v1, 4, s51
  v_mov_b32 v13, 0
sequential_preLN__gqa_block_cached__glu_gated_bilinear__decode_kernel_cntpolla:
  ds_read_b32 v12, v13 offset:1152
  s_waitcnt lgkmcnt(0)
  v_readfirstlane_b32 s51, v12
  s_nop 0
  s_cmp_ge_u32 s51, 15
  s_cbranch_scc1 sequential_preLN__gqa_block_cached__glu_gated_bilinear__decode_kernel_cntgoa
  s_cmp_eq_u32 s80, 0
  s_cbranch_scc1 sequential_preLN__gqa_block_cached__glu_gated_bilinear__decode_kernel_cntgoa
  s_sub_u32 s80, s80, 1
  s_sleep 1
  s_branch sequential_preLN__gqa_block_cached__glu_gated_bilinear__decode_kernel_cntpolla
sequential_preLN__gqa_block_cached__glu_gated_bilinear__decode_kernel_cntgoa:
  ds_read_b128 v[32:35], v6 offset:1280
  ds_read_b128 v[64:67], v7 offset:0
  ds_read_b128 v[36:39], v6 offset:1344
  ds_read_b128 v[68:71], v7 offset:1024
  ds_read_b128 v[40:43], v6 offset:1408
  ds_read_b128 v[72:75], v7 offset:2048
  ds_read_b128 v[44:47], v6 offset:1472
  ds_read_b128 v[76:79], v7 offset:3072
  ds_read_b128 v[48:51], v6 offset:1536
  ds_read_b128 v[80:83], v7 offset:4096
  ds_read_b128 v[52:55], v6 offset:1600
  ds_read_b128 v[84:87], v7 offset:5120
  ds_read_b128 v[56:59], v6 offset:1664
  ds_read_b128 v[88:91], v7 offset:6144
  s_waitcnt lgkmcnt(12)
  v_mfma_f32_16x16x32_bf16 v[28:31], v[32:35], v[64:67], 0
  s_waitcnt lgkmcnt(10)
  v_mfma_f32_16x16x32_bf16 v[28:31], v[36:39], v[68:71], v[28:31]
  s_waitcnt lgkmcnt(8)
  v_mfma_f32_16x16x32_bf16 v[28:31], v[40:43], v[72:75], v[28:31]
  s_waitcnt lgkmcnt(6)
  v_mfma_f32_16x16x32_bf16 v[28:31], v[44:47], v[76:79], v[28:31]
  s_waitcnt lgkmcnt(4)
  v_mfma_f32_16x16x32_bf16 v[28:31], v[48:51], v[80:83], v[28:31]
  s_waitcnt lgkmcnt(2)
  v_mfma_f32_16x16x32_bf16 v[28:31], v[52:55], v[84:87], v[28:31]
  s_waitcnt lgkmcnt(0)
  v_mfma_f32_16x16x32_bf16 v[28:31], v[56:59], v[88:91], v[28:31]
  ds_read_b128 v[32:35], v6 offset:1728
  ds_read_b128 v[64:67], v7 offset:7168
  ds_read_b128 v[36:39], v6 offset:1792
  ds_read_b128 v[68:71], v7 offset:8192
  ds_read_b128 v[40:43], v6 offset:1856
  ds_read_b128 v[72:75], v7 offset:9216
  ds_read_b128 v[44:47], v6 offset:1920
  ds_read_b128 v[76:79], v7 offset:10240
  ds_read_b128 v[48:51], v6 offset:1984
  ds_read_b128 v[80:83], v7 offset:11264
  ds_read_b128 v[52:55], v6 offset:2048
  ds_read_b128 v[84:87], v7 offset:12288
  ds_read_b128 v[56:59], v6 offset:2112
  ds_read_b128 v[88:91], v7 offset:13312
  s_waitcnt lgkmcnt(12)
  v_mfma_f32_16x16x32_bf16 v[28:31], v[32:35], v[64:67], v[28:31]
  s_waitcnt lgkmcnt(10)
  v_mfma_f32_16x16x32_bf16 v[28:31], v[36:39], v[68:71], v[28:31]
  s_waitcnt lgkmcnt(8)
  v_mfma_f32_16x16x32_bf16 v[28:31], v[40:43], v[72:75], v[28:31]
  s_waitcnt lgkmcnt(6)
  v_mfma_f32_16x16x32_bf16 v[28:31], v[44:47], v[76:79], v[28:31]
  s_waitcnt lgkmcnt(4)
  v_mfma_f32_16x16x32_bf16 v[28:31], v[48:51], v[80:83], v[28:31]
  s_waitcnt lgkmcnt(2)
  v_mfma_f32_16x16x32_bf16 v[28:31], v[52:55], v[84:87], v[28:31]
  s_waitcnt lgkmcnt(0)
  v_mfma_f32_16x16x32_bf16 v[28:31], v[56:59], v[88:91], v[28:31]
  v_lshlrev_b32 v6, 17, v3
  v_lshl_add_u32 v6, v2, 3, v6
  s_lshl_b32 s51, s73, 2
  s_add_u32 s51, s51, s3
  s_lshl_b32 s51, s51, 7
  s_add_u32 s51, s51, 1572864
  s_add_u32 s52, s51, 32768
  s_add_u32 s53, s51, 65536
  s_add_u32 s54, s51, 98304
  v_mov_b32 v17, s100
  v_mov_b32 v19, s100
  v_mov_b32 v21, s100
  v_mov_b32 v23, s100
  v_cvt_pk_bf16_f32 v28, v28, v29
  v_cvt_pk_bf16_f32 v30, v30, v31
  v_and_b32 v16, 0xffff, v28
  v_lshrrev_b32 v18, 16, v28
  v_and_b32 v20, 0xffff, v30
  v_lshrrev_b32 v22, 16, v30
  v_or_b32 v16, s101, v16
  v_or_b32 v18, s101, v18
  v_or_b32 v20, s101, v20
  v_or_b32 v22, s101, v22
  s_mov_b32 exec_lo, -1
  s_mov_b32 exec_hi, 0
  buffer_store_dwordx2 v[16:17], v6, s[32:35], s51 offen sc1
  buffer_store_dwordx2 v[18:19], v6, s[32:35], s52 offen sc1
  buffer_store_dwordx2 v[20:21], v6, s[32:35], s53 offen sc1
  buffer_store_dwordx2 v[22:23], v6, s[32:35], s54 offen sc1
  s_mov_b64 exec, -1
  v_mov_b32 v18, -1
  v_mov_b32 v19, -1
  v_mov_b32 v20, -1
  v_mov_b32 v21, -1
  v_mov_b32 v28, 0
  v_mov_b32 v29, 0
  v_mov_b32 v30, 0
  v_mov_b32 v31, 0
  v_mov_b32 v13, 0
  v_lshlrev_b32 v7, 4, v1
  s_branch sequential_preLN__gqa_block_cached__glu_gated_bilinear__decode_kernel_w0_resets
sequential_preLN__gqa_block_cached__glu_gated_bilinear__decode_kernel_w0_notq:
  s_waitcnt vmcnt(1)
  s_waitcnt lgkmcnt(0)
  s_add_u32 s62, s82, 1
  s_addc_u32 s63, s83, 0
  s_lshr_b64 s[100:101], s[62:63], 16
  s_lshl_b32 s101, s62, 16
sequential_preLN__gqa_block_cached__glu_gated_bilinear__decode_kernel_w0_resets:
  s_nop 1
  s_cmp_lg_u32 s96, 218
  s_cbranch_scc1 sequential_preLN__gqa_block_cached__glu_gated_bilinear__decode_kernel_nozero
  s_mov_b32 s51, 1114112
  buffer_store_dwordx4 v[28:31], v7, s[32:35], s51 offen offset:0 sc1
  buffer_store_dwordx4 v[28:31], v7, s[32:35], s51 offen offset:1024 sc1
  buffer_store_dwordx4 v[28:31], v7, s[32:35], s51 offen offset:2048 sc1
  buffer_store_dwordx4 v[28:31], v7, s[32:35], s51 offen offset:3072 sc1
  s_add_u32 s51, s51, 4096
  buffer_store_dwordx4 v[28:31], v7, s[32:35], s51 offen offset:0 sc1
  buffer_store_dwordx4 v[28:31], v7, s[32:35], s51 offen offset:1024 sc1
  buffer_store_dwordx4 v[28:31], v7, s[32:35], s51 offen offset:2048 sc1
  buffer_store_dwordx4 v[28:31], v7, s[32:35], s51 offen offset:3072 sc1
  s_add_u32 s51, s51, 4096
  buffer_store_dwordx4 v[28:31], v7, s[32:35], s51 offen offset:0 sc1
  buffer_store_dwordx4 v[28:31], v7, s[32:35], s51 offen offset:1024 sc1
  buffer_store_dwordx4 v[28:31], v7, s[32:35], s51 offen offset:2048 sc1
  buffer_store_dwordx4 v[28:31], v7, s[32:35], s51 offen offset:3072 sc1
  s_add_u32 s51, s51, 4096
  buffer_store_dwordx4 v[28:31], v7, s[32:35], s51 offen offset:0 sc1
  buffer_store_dwordx4 v[28:31], v7, s[32:35], s51 offen offset:1024 sc1
  v_mov_b32 v14, s62
  v_mov_b32 v15, s63
  s_mov_b32 s51, 1089536
  s_waitcnt vmcnt(0)
  s_mov_b64 exec, 1
  buffer_store_dwordx2 v[14:15], v13, s[32:35], s51 offen sc1
  s_mov_b64 exec, -1
sequential_preLN__gqa_block_cached__glu_gated_bilinear__decode_kernel_nozero:
  v_mov_b32 v14, s101
  v_mov_b32 v15, s100
  s_cmp_lg_u32 s47, 0
  s_cbranch_scc1 sequential_preLN__gqa_block_cached__glu_gated_bilinear__decode_kernel_nogcr
  s_waitcnt vmcnt(0)
  s_mov_b64 exec, 1
  buffer_store_dwordx2 v[14:15], v13, s[32:35], s98 offen offset:64 sc1
  s_mov_b64 exec, -1
sequential_preLN__gqa_block_cached__glu_gated_bilinear__decode_kernel_nogcr:
sequential_preLN__gqa_block_cached__glu_gated_bilinear__decode_kernel_dryret:
  s_mov_b32 s85, 0
  s_mov_b32 s26, 1867776
  s_mov_b32 s80, 0x40000
  s_mov_b64 exec, -1
  s_waitcnt vmcnt(0) lgkmcnt(0)
  v_lshlrev_b32 v5, 9, v3
  v_lshl_add_u32 v5, v2, 4, v5
  v_lshlrev_b32 v7, 4, v1
  v_mov_b32 v13, 0
  s_lshl_b32 s51, s46, 15
  s_lshl_b32 s52, s43, 12
  s_add_u32 s51, s51, s52
  s_add_u32 s51, s51, 1572864
sequential_preLN__gqa_block_cached__glu_gated_bilinear__decode_kernel_qpoll0:
  buffer_load_dwordx2 v[64:65], v13, s[32:35], s51 offen offset:4088 sc1
  s_waitcnt vmcnt(0)
  v_xor_b32 v15, s101, v64
  v_xor_b32 v14, s100, v65
  v_lshrrev_b32 v15, 16, v15
  v_or_b32 v12, v15, v14
  v_cmp_ne_u32 vcc, 0, v12
  s_nop 1
  s_cbranch_vccz sequential_preLN__gqa_block_cached__glu_gated_bilinear__decode_kernel_qpoll
  s_cmp_eq_u32 s80, 0
  s_cbranch_scc1 sequential_preLN__gqa_block_cached__glu_gated_bilinear__decode_kernel_qpoll
  s_sub_u32 s80, s80, 1
  s_sleep 8
  s_branch sequential_preLN__gqa_block_cached__glu_gated_bilinear__decode_kernel_qpoll0
sequential_preLN__gqa_block_cached__glu_gated_bilinear__decode_kernel_qpoll:
  buffer_load_dwordx4 v[64:67], v7, s[32:35], s51 offen offset:0 sc1
  buffer_load_dwordx4 v[68:71], v7, s[32:35], s51 offen offset:1024 sc1
  buffer_load_dwordx4 v[72:75], v7, s[32:35], s51 offen offset:2048 sc1
  buffer_load_dwordx4 v[76:79], v7, s[32:35], s51 offen offset:3072 sc1
  buffer_load_dwordx2 v[80:81], v13, s[32:35], s98 offen offset:64 sc1
  s_waitcnt vmcnt(0)
  v_mov_b32 v12, 0
  v_xor_b32 v15, s101, v64
  v_xor_b32 v14, s100, v65
  v_lshrrev_b32 v15, 16, v15
  v_or3_b32 v12, v12, v15, v14
  v_xor_b32 v15, s101, v66
  v_xor_b32 v14, s100, v67
  v_lshrrev_b32 v15, 16, v15
  v_or3_b32 v12, v12, v15, v14
  v_xor_b32 v15, s101, v68
  v_xor_b32 v14, s100, v69
  v_lshrrev_b32 v15, 16, v15
  v_or3_b32 v12, v12, v15, v14
  v_xor_b32 v15, s101, v70
  v_xor_b32 v14, s100, v71
  v_lshrrev_b32 v15, 16, v15
  v_or3_b32 v12, v12, v15, v14
  v_xor_b32 v15, s101, v72
  v_xor_b32 v14, s100, v73
  v_lshrrev_b32 v15, 16, v15
  v_or3_b32 v12, v12, v15, v14
  v_xor_b32 v15, s101, v74
  v_xor_b32 v14, s100, v75
  v_lshrrev_b32 v15, 16, v15
  v_or3_b32 v12, v12, v15, v14
  v_xor_b32 v15, s101, v76
  v_xor_b32 v14, s100, v77
  v_lshrrev_b32 v15, 16, v15
  v_or3_b32 v12, v12, v15, v14
  v_xor_b32 v15, s101, v78
  v_xor_b32 v14, s100, v79
  v_lshrrev_b32 v15, 16, v15
  v_or3_b32 v12, v12, v15, v14
  v_xor_b32 v15, s101, v80
  v_xor_b32 v14, s100, v81
  v_lshrrev_b32 v15, 16, v15
  v_or3_b32 v12, v12, v15, v14
  v_cmp_ne_u32 vcc, 0, v12
  s_nop 1
  s_cbranch_vccz sequential_preLN__gqa_block_cached__glu_gated_bilinear__decode_kernel_qgo
  s_cmp_eq_u32 s80, 0
  s_cbranch_scc1 sequential_preLN__gqa_block_cached__glu_gated_bilinear__decode_kernel_qgo
  s_sub_u32 s80, s80, 1
  s_sleep 4
  s_branch sequential_preLN__gqa_block_cached__glu_gated_bilinear__decode_kernel_qpoll
sequential_preLN__gqa_block_cached__glu_gated_bilinear__decode_kernel_qgo:
  v_lshlrev_b32 v6, 2, v1
  v_perm_b32 v16, v66, v64, s41
  v_perm_b32 v17, v70, v68, s41
  v_perm_b32 v18, v74, v72, s41
  v_perm_b32 v19, v78, v76, s41
  ds_write_b32 v6, v16 offset:0
  ds_write_b32 v6, v17 offset:256
  ds_write_b32 v6, v18 offset:512
  ds_write_b32 v6, v19 offset:768
  v_mov_b32 v12, 1
  v_mov_b32 v13, 0
  s_waitcnt lgkmcnt(0)
  ds_write_b32 v13, v12 offset:1156
  v_mov_b32 v28, -1
  v_mov_b32 v29, -1
  v_mov_b32 v30, -1
  v_mov_b32 v31, -1
  v_lshrrev_b32 v12, 3, v1
  v_mul_u32_u24 v12, 3584, v12
  v_and_b32 v14, 7, v1
  v_lshl_add_u32 v12, v14, 4, v12
  s_lshl_b32 s51, s73, 7
  s_add_u32 s51, s51, 1146880
  s_cmp_lg_u32 s72, 3
  s_cselect_b32 s51, s34, s51
  buffer_store_dwordx4 v[28:31], v12, s[32:35], s51 offen sc1
  s_waitcnt vmcnt(4)
  buffer_load_dwordx4 v[128:131], v4, s[16:19], s36 offen offset:0 nt
  buffer_load_dwordx4 v[132:135], v4, s[16:19], s36 offen offset:2048 nt
  s_waitcnt vmcnt(4)
  buffer_load_dwordx4 v[136:139], v4, s[16:19], s37 offen offset:0 nt
  buffer_load_dwordx4 v[140:143], v4, s[16:19], s37 offen offset:2048 nt
  s_waitcnt vmcnt(4)
  buffer_load_dwordx4 v[144:147], v4, s[16:19], s38 offen offset:0 nt
  buffer_load_dwordx4 v[148:151], v4, s[16:19], s38 offen offset:2048 nt
  s_waitcnt vmcnt(4)
  buffer_load_dwordx4 v[152:155], v4, s[16:19], s39 offen offset:0 nt
  buffer_load_dwordx4 v[156:159], v4, s[16:19], s39 offen offset:2048 nt
  s_waitcnt vmcnt(4)
  buffer_load_dwordx4 v[160:163], v4, s[16:19], s36 offen offset:256 nt
  buffer_load_dwordx4 v[164:167], v4, s[16:19], s36 offen offset:2304 nt
  s_waitcnt vmcnt(4)
  buffer_load_dwordx4 v[168:171], v4, s[16:19], s37 offen offset:256 nt
  buffer_load_dwordx4 v[172:175], v4, s[16:19], s37 offen offset:2304 nt
  s_waitcnt vmcnt(4)
  buffer_load_dwordx4 v[176:179], v4, s[16:19], s38 offen offset:256 nt
  buffer_load_dwordx4 v[180:183], v4, s[16:19], s38 offen offset:2304 nt
  s_waitcnt vmcnt(4)
  buffer_load_dwordx4 v[184:187], v4, s[16:19], s39 offen offset:256 nt
  buffer_load_dwordx4 v[188:191], v4, s[16:19], s39 offen offset:2304 nt
  s_waitcnt vmcnt(4)
  buffer_load_dwordx4 v[192:195], v5, s[20:23], s8 offen offset:0 nt
  buffer_load_dwordx4 v[196:199], v5, s[20:23], s8 offen offset:2048 nt
  s_waitcnt vmcnt(4)
  buffer_load_dwordx4 v[200:203], v5, s[20:23], s9 offen offset:0 nt
  buffer_load_dwordx4 v[204:207], v5, s[20:23], s9 offen offset:2048 nt
  s_waitcnt vmcnt(4)
  buffer_load_dwordx4 v[208:211], v5, s[20:23], s10 offen offset:0 nt
  buffer_load_dwordx4 v[212:215], v5, s[20:23], s10 offen offset:2048 nt
  s_waitcnt vmcnt(4)
  buffer_load_dwordx4 v[216:219], v5, s[20:23], s11 offen offset:0 nt
  buffer_load_dwordx4 v[220:223], v5, s[20:23], s11 offen offset:2048 nt
  s_waitcnt vmcnt(4)
  buffer_load_dwordx4 v[224:227], v5, s[20:23], s8 offen offset:256 nt
  buffer_load_dwordx4 v[228:231], v5, s[20:23], s8 offen offset:2304 nt
  s_waitcnt vmcnt(4)
  buffer_load_dwordx4 v[232:235], v5, s[20:23], s9 offen offset:256 nt
  buffer_load_dwordx4 v[236:239], v5, s[20:23], s9 offen offset:2304 nt
  s_waitcnt vmcnt(4)
  buffer_load_dwordx4 v[240:243], v5, s[20:23], s10 offen offset:256 nt
  buffer_load_dwordx4 v[244:247], v5, s[20:23], s10 offen offset:2304 nt
  s_waitcnt vmcnt(4)
  buffer_load_dwordx4 v[248:251], v5, s[20:23], s11 offen offset:256 nt
  buffer_load_dwordx4 v[252:255], v5, s[20:23], s11 offen offset:2304 nt
  s_waitcnt vmcnt(4)
  buffer_load_dwordx4 v[64:67], v4, s[16:19], s8 offen offset:0 nt
  buffer_load_dwordx4 v[68:71], v4, s[16:19], s8 offen offset:2048 nt
  s_waitcnt vmcnt(4)
  buffer_load_dwordx4 v[72:75], v4, s[16:19], s9 offen offset:0 nt
  buffer_load_dwordx4 v[76:79], v4, s[16:19], s9 offen offset:2048 nt
  s_waitcnt vmcnt(4)
  buffer_load_dwordx4 v[80:83], v4, s[16:19], s10 offen offset:0 nt
  buffer_load_dwordx4 v[84:87], v4, s[16:19], s10 offen offset:2048 nt
  s_waitcnt vmcnt(4)
  buffer_load_dwordx4 v[88:91], v4, s[16:19], s11 offen offset:0 nt
  buffer_load_dwordx4 v[92:95], v4, s[16:19], s11 offen offset:2048 nt
  s_waitcnt vmcnt(4)
  buffer_load_dwordx4 v[96:99], v4, s[16:19], s8 offen offset:256 nt
  buffer_load_dwordx4 v[100:103], v4, s[16:19], s8 offen offset:2304 nt
  s_waitcnt vmcnt(4)
  buffer_load_dwordx4 v[104:107], v4, s[16:19], s9 offen offset:256 nt
  buffer_load_dwordx4 v[108:111], v4, s[16:19], s9 offen offset:2304 nt
  s_waitcnt vmcnt(4)
  buffer_load_dwordx4 v[112:115], v4, s[16:19], s10 offen offset:256 nt
  buffer_load_dwordx4 v[116:119], v4, s[16:19], s10 offen offset:2304 nt
  s_waitcnt vmcnt(4)
  buffer_load_dwordx4 v[120:123], v4, s[16:19], s11 offen offset:256 nt
  buffer_load_dwordx4 v[124:127], v4, s[16:19], s11 offen offset:2304 nt
  s_branch sequential_preLN__gqa_block_cached__glu_gated_bilinear__decode_kernel_join
sequential_preLN__gqa_block_cached__glu_gated_bilinear__decode_kernel_w17:
  s_sub_u32 s53, s3, 1
  s_cmp_eq_u32 s72, 2
  s_cbranch_scc1 sequential_preLN__gqa_block_cached__glu_gated_bilinear__decode_kernel_rQ
  s_cmp_eq_u32 s72, 3
  s_cbranch_scc1 sequential_preLN__gqa_block_cached__glu_gated_bilinear__decode_kernel_rB
  s_cmp_eq_u32 s72, 4
  s_cbranch_scc1 sequential_preLN__gqa_block_cached__glu_gated_bilinear__decode_kernel_rC
  s_cmp_lg_u32 s72, 1
  s_cbranch_scc1 sequential_preLN__gqa_block_cached__glu_gated_bilinear__decode_kernel_fill0
  s_cmp_lt_u32 s3, 4
  s_cbranch_scc1 sequential_preLN__gqa_block_cached__glu_gated_bilinear__decode_kernel_fill0
  s_mov_b32 s56, s60
  s_mov_b32 s57, s61
  s_mov_b32 s58, 3670016
  s_sub_u32 s53, s3, 4
  v_lshrrev_b32 v12, 3, v1
  v_mul_u32_u24 v6, 7168, v12
  v_and_b32 v13, 7, v1
  v_lshl_add_u32 v6, v13, 4, v6
  s_and_b32 s51, s73, 15
  s_lshl_b32 s51, s51, 2
  s_add_u32 s51, s51, s53
  s_mul_i32 s51, s51, 57344
  s_lshr_b32 s54, s73, 4
  s_lshl_b32 s54, s54, 7
  s_add_u32 s51, s51, s54
  s_mov_b32 s52, 896
  v_lshrrev_b32 v24, 5, v1
  v_lshlrev_b32 v24, 12, v24
  v_lshrrev_b32 v14, 1, v13
  v_lshl_add_u32 v24, v14, 10, v24
  v_and_b32 v14, 3, v12
  v_lshl_add_u32 v24, v14, 8, v24
  v_and_b32 v14, 1, v1
  v_lshl_add_u32 v24, v14, 7, v24
  s_lshl_b32 s54, s53, 13
  s_add_u32 s54, s54, 29696
  v_add_u32 v24, s54, v24
  buffer_load_dwordx4 v[64:67], v6, s[56:59], s51 offen nt
  s_add_u32 s51, s51, s52
  buffer_load_dwordx4 v[68:71], v6, s[56:59], s51 offen nt
  s_add_u32 s51, s51, s52
  buffer_load_dwordx4 v[72:75], v6, s[56:59], s51 offen nt
  s_add_u32 s51, s51, s52
  buffer_load_dwordx4 v[76:79], v6, s[56:59], s51 offen nt
  s_add_u32 s51, s51, s52
  buffer_load_dwordx4 v[80:83], v6, s[56:59], s51 offen nt
  s_add_u32 s51, s51, s52
  buffer_load_dwordx4 v[84:87], v6, s[56:59], s51 offen nt
  s_add_u32 s51, s51, s52
  buffer_load_dwordx4 v[88:91], v6, s[56:59], s51 offen nt
  s_add_u32 s51, s51, s52
  buffer_load_dwordx4 v[92:95], v6, s[56:59], s51 offen nt
  s_add_u32 s51, s51, s52
  buffer_load_dwordx4 v[128:131], v4, s[16:19], s36 offen offset:0 nt
  buffer_load_dwordx4 v[132:135], v4, s[16:19], s36 offen offset:2048 nt
  buffer_load_dwordx4 v[136:139], v4, s[16:19], s37 offen offset:0 nt
  buffer_load_dwordx4 v[140:143], v4, s[16:19], s37 offen offset:2048 nt
  s_waitcnt vmcnt(4)
  v_perm_b32 v32, v68, v64, s41
  v_perm_b32 v33, v76, v72, s41
  v_perm_b32 v34, v84, v80, s41
  v_perm_b32 v35, v92, v88, s41
  v_perm_b32 v36, v68, v64, s42
  v_perm_b32 v37, v76, v72, s42
  v_perm_b32 v38, v84, v80, s42
  v_perm_b32 v39, v92, v88, s42
  v_perm_b32 v40, v69, v65, s41
  v_perm_b32 v41, v77, v73, s41
  v_perm_b32 v42, v85, v81, s41
  v_perm_b32 v43, v93, v89, s41
  v_perm_b32 v44, v69, v65, s42
  v_perm_b32 v45, v77, v73, s42
  v_perm_b32 v46, v85, v81, s42
  v_perm_b32 v47, v93, v89, s42
  v_perm_b32 v48, v70, v66, s41
  v_perm_b32 v49, v78, v74, s41
  v_perm_b32 v50, v86, v82, s41
  v_perm_b32 v51, v94, v90, s41
  v_perm_b32 v52, v70, v66, s42
  v_perm_b32 v53, v78, v74, s42
  v_perm_b32 v54, v86, v82, s42
  v_perm_b32 v55, v94, v90, s42
  v_perm_b32 v56, v71, v67, s41
  v_perm_b32 v57, v79, v75, s41
  v_perm_b32 v58, v87, v83, s41
  v_perm_b32 v59, v95, v91, s41
  v_perm_b32 v60, v71, v67, s42
  v_perm_b32 v61, v79, v75, s42
  v_perm_b32 v62, v87, v83, s42
  v_perm_b32 v63, v95, v91, s42
  ds_write_b128 v24, v[32:35] offset:0
  ds_write_b128 v24, v[36:39] offset:16
  ds_write_b128 v24, v[40:43] offset:32
  ds_write_b128 v24, v[44:47] offset:48
  ds_write_b128 v24, v[48:51] offset:64
  ds_write_b128 v24, v[52:55] offset:80
  ds_write_b128 v24, v[56:59] offset:96
  ds_write_b128 v24, v[60:63] offset:112
  s_waitcnt lgkmcnt(0)
  s_branch sequential_preLN__gqa_block_cached__glu_gated_bilinear__decode_kernel_fill4
sequential_preLN__gqa_block_cached__glu_gated_bilinear__decode_kernel_rQ:
  s_mov_b32 s56, s74
  s_mov_b32 s57, s75
  s_mov_b32 s58, 3670016
  v_lshrrev_b32 v12, 3, v1
  v_lshlrev_b32 v6, 16, v12
  v_and_b32 v13, 7, v1
  v_lshl_add_u32 v6, v13, 4, v6
  s_lshl_b32 s51, s53, 19
  s_lshl_b32 s54, s73, 7
  s_add_u32 s51, s51, s54
  s_mov_b32 s52, 8192
  v_lshrrev_b32 v14, 1, v13
  v_mul_u32_u24 v24, 14336, v14
  v_lshl_add_u32 v24, v12, 8, v24
  v_and_b32 v14, 1, v1
  v_lshl_add_u32 v24, v14, 7, v24
  s_lshl_b32 s54, s53, 11
  s_add_u32 s54, s54, 29696
  v_add_u32 v24, s54, v24
  buffer_load_dwordx4 v[64:67], v6, s[56:59], s51 offen nt
  s_add_u32 s51, s51, s52
  buffer_load_dwordx4 v[68:71], v6, s[56:59], s51 offen nt
  s_add_u32 s51, s51, s52
  buffer_load_dwordx4 v[72:75], v6, s[56:59], s51 offen nt
  s_add_u32 s51, s51, s52
  buffer_load_dwordx4 v[76:79], v6, s[56:59], s51 offen nt
  s_add_u32 s51, s51, s52
  buffer_load_dwordx4 v[80:83], v6, s[56:59], s51 offen nt
  s_add_u32 s51, s51, s52
  buffer_load_dwordx4 v[84:87], v6, s[56:59], s51 offen nt
  s_add_u32 s51, s51, s52
  buffer_load_dwordx4 v[88:91], v6, s[56:59], s51 offen nt
  s_add_u32 s51, s51, s52
  buffer_load_dwordx4 v[92:95], v6, s[56:59], s51 offen nt
  s_add_u32 s51, s51, s52
  buffer_load_dwordx4 v[128:131], v4, s[16:19], s36 offen offset:0 nt
  buffer_load_dwordx4 v[132:135], v4, s[16:19], s36 offen offset:2048 nt
  buffer_load_dwordx4 v[136:139], v4, s[16:19], s37 offen offset:0 nt
  buffer_load_dwordx4 v[140:143], v4, s[16:19], s37 offen offset:2048 nt
  s_waitcnt vmcnt(12)
  s_waitcnt lgkmcnt(0)
  s_add_u32 s62, s82, 1
  s_addc_u32 s63, s83, 0
  s_lshr_b64 s[100:101], s[62:63], 16
  s_lshl_b32 s101, s62, 16
  v_lshlrev_b32 v32, 16, v8
  v_and_b32 v33, s44, v8
  v_lshlrev_b32 v34, 16, v9
  v_and_b32 v35, s44, v9
  v_lshlrev_b32 v36, 16, v10
  v_and_b32 v37, s44, v10
  v_lshlrev_b32 v38, 16, v11
  v_and_b32 v39, s44, v11
  v_readfirstlane_b32 s51, v32
  v_cmp_gt_u32 vcc, 56, v1
  s_nop 0
  v_subrev_f32 v40, s51, v32
  v_subrev_f32 v42, s51, v33
  v_mul_f32 v41, v40, v40
  v_add_f32 v40, v40, v42
  v_fmac_f32 v41, v42, v42
  v_subrev_f32 v42, s51, v34
  v_add_f32 v40, v40, v42
  v_fmac_f32 v41, v42, v42
  v_subrev_f32 v43, s51, v35
  v_add_f32 v40, v40, v43
  v_fmac_f32 v41, v43, v43
  v_subrev_f32 v42, s51, v36
  v_add_f32 v40, v40, v42
  v_fmac_f32 v41, v42, v42
  v_subrev_f32 v43, s51, v37
  v_add_f32 v40, v40, v43
  v_fmac_f32 v41, v43, v43
  v_subrev_f32 v42, s51, v38
  v_add_f32 v40, v40, v42
  v_fmac_f32 v41, v42, v42
  v_subrev_f32 v43, s51, v39
  v_add_f32 v40, v40, v43
  v_fmac_f32 v41, v43, v43
  v_cndmask_b32 v40, 0, v40, vcc
  v_cndmask_b32 v41, 0, v41, vcc
  s_nop 0
  v_add_f32_dpp v40, v40, v40 quad_perm:[1,0,3,2] row_mask:0xf bank_mask:0xf
  v_add_f32_dpp v41, v41, v41 quad_perm:[1,0,3,2] row_mask:0xf bank_mask:0xf
  s_nop 0
  v_add_f32_dpp v40, v40, v40 quad_perm:[2,3,0,1] row_mask:0xf bank_mask:0xf
  v_add_f32_dpp v41, v41, v41 quad_perm:[2,3,0,1] row_mask:0xf bank_mask:0xf
  s_nop 0
  v_add_f32_dpp v40, v40, v40 row_half_mirror row_mask:0xf bank_mask:0xf
  v_add_f32_dpp v41, v41, v41 row_half_mirror row_mask:0xf bank_mask:0xf
  s_nop 0
  v_add_f32_dpp v40, v40, v40 row_mirror row_mask:0xf bank_mask:0xf
  v_add_f32_dpp v41, v41, v41 row_mirror row_mask:0xf bank_mask:0xf
  v_mov_b32 v42, v40
  v_mov_b32 v43, v41
  s_nop 0
  v_permlane16_swap_b32 v40, v42
  v_permlane16_swap_b32 v41, v43
  v_add_f32 v40, v40, v42
  v_add_f32 v41, v41, v43
  v_mov_b32 v42, v40
  v_mov_b32 v43, v41
  s_nop 0
  v_permlane32_swap_b32 v40, v42
  v_permlane32_swap_b32 v41, v43
  v_add_f32 v40, v40, v42
  v_add_f32 v41, v41, v43
  v_mul_f32 v40, 0x3b124925, v40
  v_mul_f32 v41, 0x3b124925, v41
  v_fma_f32 v41, -v40, v40, v41
  v_max_f32 v41, 0, v41
  v_add_f32 v40, s51, v40
  v_cvt_pk_bf16_f32 v42, v40, v41
  v_lshlrev_b32 v40, 16, v42
  v_and_b32 v41, s44, v42
  v_add_f32 v41, 0x3727c5ac, v41
  v_cvt_pk_bf16_f32 v41, v41, v41
  v_lshlrev_b32 v41, 16, v41
  v_sqrt_f32 v41, v41
  v_sub_f32 v32, v32, v40
  v_sub_f32 v33, v33, v40
  v_sub_f32 v34, v34, v40
  v_sub_f32 v35, v35, v40
  v_sub_f32 v36, v36, v40
  v_sub_f32 v37, v37, v40
  v_sub_f32 v38, v38, v40
  v_sub_f32 v39, v39, v40
  v_cvt_pk_bf16_f32 v41, v41, v41
  v_lshlrev_b32 v41, 16, v41
  v_rcp_f32 v41, v41
  v_cvt_pk_bf16_f32 v42, v32, v33
  v_lshlrev_b32 v32, 16, v42
  v_and_b32 v33, s44, v42
  v_mul_f32 v32, v32, v41
  v_mul_f32 v33, v33, v41
  v_cvt_pk_bf16_f32 v8, v32, v33
  v_cvt_pk_bf16_f32 v42, v34, v35
  v_lshlrev_b32 v34, 16, v42
  v_and_b32 v35, s44, v42
  v_mul_f32 v34, v34, v41
  v_mul_f32 v35, v35, v41
  v_cvt_pk_bf16_f32 v9, v34, v35
  v_cvt_pk_bf16_f32 v42, v36, v37
  v_lshlrev_b32 v36, 16, v42
  v_and_b32 v37, s44, v42
  v_mul_f32 v36, v36, v41
  v_mul_f32 v37, v37, v41
  v_cvt_pk_bf16_f32 v10, v36, v37
  v_cvt_pk_bf16_f32 v42, v38, v39
  v_lshlrev_b32 v38, 16, v42
  v_and_b32 v39, s44, v42
  v_mul_f32 v38, v38, v41
  v_mul_f32 v39, v39, v41
  v_cvt_pk_bf16_f32 v11, v38, v39
  s_mul_i32 s51, s3, 1056
  v_lshl_add_u32 v12, v1, 4, s51
  ds_write_b128 v12, v[8:11] offset:1280
  v_mov_b32 v12, 1
  v_mov_b32 v13, 0
  s_waitcnt lgkmcnt(0)
  s_mov_b64 exec, 1
  ds_add_u32 v13, v12 offset:1152
  s_mov_b64 exec, -1
  s_waitcnt vmcnt(4)
  v_perm_b32 v32, v68, v64, s41
  v_perm_b32 v33, v76, v72, s41
  v_perm_b32 v34, v84, v80, s41
  v_perm_b32 v35, v92, v88, s41
  v_perm_b32 v36, v68, v64, s42
  v_perm_b32 v37, v76, v72, s42
  v_perm_b32 v38, v84, v80, s42
  v_perm_b32 v39, v92, v88, s42
  v_perm_b32 v40, v69, v65, s41
  v_perm_b32 v41, v77, v73, s41
  v_perm_b32 v42, v85, v81, s41
  v_perm_b32 v43, v93, v89, s41
  v_perm_b32 v44, v69, v65, s42
  v_perm_b32 v45, v77, v73, s42
  v_perm_b32 v46, v85, v81, s42
  v_perm_b32 v47, v93, v89, s42
  v_perm_b32 v48, v70, v66, s41
  v_perm_b32 v49, v78, v74, s41
  v_perm_b32 v50, v86, v82, s41
  v_perm_b32 v51, v94, v90, s41
  v_perm_b32 v52, v70, v66, s42
  v_perm_b32 v53, v78, v74, s42
  v_perm_b32 v54, v86, v82, s42
  v_perm_b32 v55, v94, v90, s42
  v_perm_b32 v56, v71, v67, s41
  v_perm_b32 v57, v79, v75, s41
  v_perm_b32 v58, v87, v83, s41
  v_perm_b32 v59, v95, v91, s41
  v_perm_b32 v60, v71, v67, s42
  v_perm_b32 v61, v79, v75, s42
  v_perm_b32 v62, v87, v83, s42
  v_perm_b32 v63, v95, v91, s42
  ds_write_b128 v24, v[32:35] offset:0
  ds_write_b128 v24, v[36:39] offset:16
  ds_write_b128 v24, v[40:43] offset:32
  ds_write_b128 v24, v[44:47] offset:48
  ds_write_b128 v24, v[48:51] offset:64
  ds_write_b128 v24, v[52:55] offset:80
  ds_write_b128 v24, v[56:59] offset:96
  ds_write_b128 v24, v[60:63] offset:112
  s_waitcnt lgkmcnt(0)
  v_mov_b32 v12, 1
  v_mov_b32 v13, 0
  s_waitcnt lgkmcnt(0)
  s_mov_b64 exec, 1
  ds_add_u32 v13, v12 offset:1152
  s_mov_b64 exec, -1
  s_cmp_ge_u32 s3, 4
  s_cbranch_scc1 sequential_preLN__gqa_block_cached__glu_gated_bilinear__decode_kernel_fill4
  v_and_b32 v6, 7, v2
  v_mul_u32_u24 v6, 1056, v6
  v_lshl_add_u32 v6, v3, 4, v6
  s_mul_i32 s51, s3, 14336
  s_add_u32 s51, s51, 29696
  v_lshl_add_u32 v7, v1, 4, s51
  v_mov_b32 v13, 0
sequential_preLN__gqa_block_cached__glu_gated_bilinear__decode_kernel_cntpollb:
  ds_read_b32 v12, v13 offset:1152
  s_waitcnt lgkmcnt(0)
  v_readfirstlane_b32 s51, v12
  s_nop 0
  s_cmp_ge_u32 s51, 15
  s_cbranch_scc1 sequential_preLN__gqa_block_cached__glu_gated_bilinear__decode_kernel_cntgob
  s_cmp_eq_u32 s80, 0
  s_cbranch_scc1 sequential_preLN__gqa_block_cached__glu_gated_bilinear__decode_kernel_cntgob
  s_sub_u32 s80, s80, 1
  s_sleep 1
  s_branch sequential_preLN__gqa_block_cached__glu_gated_bilinear__decode_kernel_cntpollb
sequential_preLN__gqa_block_cached__glu_gated_bilinear__decode_kernel_cntgob:
  ds_read_b128 v[32:35], v6 offset:1280
  ds_read_b128 v[64:67], v7 offset:0
  ds_read_b128 v[36:39], v6 offset:1344
  ds_read_b128 v[68:71], v7 offset:1024
  ds_read_b128 v[40:43], v6 offset:1408
  ds_read_b128 v[72:75], v7 offset:2048
  ds_read_b128 v[44:47], v6 offset:1472
  ds_read_b128 v[76:79], v7 offset:3072
  ds_read_b128 v[48:51], v6 offset:1536
  ds_read_b128 v[80:83], v7 offset:4096
  ds_read_b128 v[52:55], v6 offset:1600
  ds_read_b128 v[84:87], v7 offset:5120
  ds_read_b128 v[56:59], v6 offset:1664
  ds_read_b128 v[88:91], v7 offset:6144
  s_waitcnt lgkmcnt(12)
  v_mfma_f32_16x16x32_bf16 v[28:31], v[32:35], v[64:67], 0
  s_waitcnt lgkmcnt(10)
  v_mfma_f32_16x16x32_bf16 v[28:31], v[36:39], v[68:71], v[28:31]
  s_waitcnt lgkmcnt(8)
  v_mfma_f32_16x16x32_bf16 v[28:31], v[40:43], v[72:75], v[28:31]
  s_waitcnt lgkmcnt(6)
  v_mfma_f32_16x16x32_bf16 v[28:31], v[44:47], v[76:79], v[28:31]
  s_waitcnt lgkmcnt(4)
  v_mfma_f32_16x16x32_bf16 v[28:31], v[48:51], v[80:83], v[28:31]
  s_waitcnt lgkmcnt(2)
  v_mfma_f32_16x16x32_bf16 v[28:31], v[52:55], v[84:87], v[28:31]
  s_waitcnt lgkmcnt(0)
  v_mfma_f32_16x16x32_bf16 v[28:31], v[56:59], v[88:91], v[28:31]
  ds_read_b128 v[32:35], v6 offset:1728
  ds_read_b128 v[64:67], v7 offset:7168
  ds_read_b128 v[36:39], v6 offset:1792
  ds_read_b128 v[68:71], v7 offset:8192
  ds_read_b128 v[40:43], v6 offset:1856
  ds_read_b128 v[72:75], v7 offset:9216
  ds_read_b128 v[44:47], v6 offset:1920
  ds_read_b128 v[76:79], v7 offset:10240
  ds_read_b128 v[48:51], v6 offset:1984
  ds_read_b128 v[80:83], v7 offset:11264
  ds_read_b128 v[52:55], v6 offset:2048
  ds_read_b128 v[84:87], v7 offset:12288
  ds_read_b128 v[56:59], v6 offset:2112
  ds_read_b128 v[88:91], v7 offset:13312
  s_waitcnt lgkmcnt(12)
  v_mfma_f32_16x16x32_bf16 v[28:31], v[32:35], v[64:67], v[28:31]
  s_waitcnt lgkmcnt(10)
  v_mfma_f32_16x16x32_bf16 v[28:31], v[36:39], v[68:71], v[28:31]
  s_waitcnt lgkmcnt(8)
  v_mfma_f32_16x16x32_bf16 v[28:31], v[40:43], v[72:75], v[28:31]
  s_waitcnt lgkmcnt(6)
  v_mfma_f32_16x16x32_bf16 v[28:31], v[44:47], v[76:79], v[28:31]
  s_waitcnt lgkmcnt(4)
  v_mfma_f32_16x16x32_bf16 v[28:31], v[48:51], v[80:83], v[28:31]
  s_waitcnt lgkmcnt(2)
  v_mfma_f32_16x16x32_bf16 v[28:31], v[52:55], v[84:87], v[28:31]
  s_waitcnt lgkmcnt(0)
  v_mfma_f32_16x16x32_bf16 v[28:31], v[56:59], v[88:91], v[28:31]
  v_lshlrev_b32 v6, 17, v3
  v_lshl_add_u32 v6, v2, 3, v6
  s_lshl_b32 s51, s73, 2
  s_add_u32 s51, s51, s3
  s_lshl_b32 s51, s51, 7
  s_add_u32 s51, s51, 1572864
  s_add_u32 s52, s51, 32768
  s_add_u32 s53, s51, 65536
  s_add_u32 s54, s51, 98304
  v_mov_b32 v17, s100
  v_mov_b32 v19, s100
  v_mov_b32 v21, s100
  v_mov_b32 v23, s100
  v_cvt_pk_bf16_f32 v28, v28, v29
  v_cvt_pk_bf16_f32 v30, v30, v31
  v_and_b32 v16, 0xffff, v28
  v_lshrrev_b32 v18, 16, v28
  v_and_b32 v20, 0xffff, v30
  v_lshrrev_b32 v22, 16, v30
  v_or_b32 v16, s101, v16
  v_or_b32 v18, s101, v18
  v_or_b32 v20, s101, v20
  v_or_b32 v22, s101, v22
  s_mov_b32 exec_lo, -1
  s_mov_b32 exec_hi, 0
  buffer_store_dwordx2 v[16:17], v6, s[32:35], s51 offen sc1
  buffer_store_dwordx2 v[18:19], v6, s[32:35], s52 offen sc1
  buffer_store_dwordx2 v[20:21], v6, s[32:35], s53 offen sc1
  buffer_store_dwordx2 v[22:23], v6, s[32:35], s54 offen sc1
  s_mov_b64 exec, -1
  s_branch sequential_preLN__gqa_block_cached__glu_gated_bilinear__decode_kernel_fill4
sequential_preLN__gqa_block_cached__glu_gated_bilinear__decode_kernel_rB:
  s_sub_u32 s53, s3, 1
  s_mov_b32 s56, s64
  s_mov_b32 s57, s65
  s_mov_b32 s58, 1605632
  s_mov_b32 s59, 0x00020000
  v_lshrrev_b32 v12, 3, v1
  v_mul_u32_u24 v6, 28672, v12
  v_and_b32 v13, 7, v1
  v_lshl_add_u32 v6, v13, 4, v6
  s_mul_i32 s51, s53, 229376
  s_lshl_b32 s54, s73, 7
  s_add_u32 s51, s51, s54
  s_mov_b32 s40, s51
  s_mov_b32 s52, 3584
  v_mul_u32_u24 v24, 14336, v13
  v_lshl_add_u32 v24, v12, 8, v24
  s_lshl_b32 s54, s53, 11
  s_add_u32 s54, s54, 29696
  v_add_u32 v24, s54, v24
  buffer_load_dwordx4 v[64:67], v6, s[56:59], s51 offen nt
  s_add_u32 s51, s51, s52
  buffer_load_dwordx4 v[68:71], v6, s[56:59], s51 offen nt
  s_add_u32 s51, s51, s52
  buffer_load_dwordx4 v[72:75], v6, s[56:59], s51 offen nt
  s_add_u32 s51, s51, s52
  buffer_load_dwordx4 v[76:79], v6, s[56:59], s51 offen nt
  s_add_u32 s51, s51, s52
  buffer_load_dwordx4 v[80:83], v6, s[56:59], s51 offen nt
  s_add_u32 s51, s51, s52
  buffer_load_dwordx4 v[84:87], v6, s[56:59], s51 offen nt
  s_add_u32 s51, s51, s52
  buffer_load_dwordx4 v[88:91], v6, s[56:59], s51 offen nt
  s_add_u32 s51, s51, s52
  buffer_load_dwordx4 v[92:95], v6, s[56:59], s51 offen nt
  s_add_u32 s51, s51, s52
  s_mov_b32 s56, s66
  s_mov_b32 s57, s67
  buffer_load_dwordx4 v[96:99], v6, s[56:59], s40 offen nt
  s_add_u32 s40, s40, s52
  buffer_load_dwordx4 v[100:103], v6, s[56:59], s40 offen nt
  s_add_u32 s40, s40, s52
  buffer_load_dwordx4 v[104:107], v6, s[56:59], s40 offen nt
  s_add_u32 s40, s40, s52
  buffer_load_dwordx4 v[108:111], v6, s[56:59], s40 offen nt
  s_add_u32 s40, s40, s52
  buffer_load_dwordx4 v[112:115], v6, s[56:59], s40 offen nt
  s_add_u32 s40, s40, s52
  buffer_load_dwordx4 v[116:119], v6, s[56:59], s40 offen nt
  s_add_u32 s40, s40, s52
  buffer_load_dwordx4 v[120:123], v6, s[56:59], s40 offen nt
  s_add_u32 s40, s40, s52
  buffer_load_dwordx4 v[124:127], v6, s[56:59], s40 offen nt
  s_add_u32 s40, s40, s52
  buffer_load_dwordx4 v[128:131], v4, s[16:19], s36 offen offset:0 nt
  buffer_load_dwordx4 v[132:135], v4, s[16:19], s36 offen offset:2048 nt
  buffer_load_dwordx4 v[136:139], v4, s[16:19], s37 offen offset:0 nt
  buffer_load_dwordx4 v[140:143], v4, s[16:19], s37 offen offset:2048 nt
  s_waitcnt vmcnt(12)
  v_perm_b32 v32, v68, v64, s41
  v_perm_b32 v33, v76, v72, s41
  v_perm_b32 v34, v84, v80, s41
  v_perm_b32 v35, v92, v88, s41
  v_perm_b32 v36, v68, v64, s42
  v_perm_b32 v37, v76, v72, s42
  v_perm_b32 v38, v84, v80, s42
  v_perm_b32 v39, v92, v88, s42
  v_perm_b32 v40, v69, v65, s41
  v_perm_b32 v41, v77, v73, s41
  v_perm_b32 v42, v85, v81, s41
  v_perm_b32 v43, v93, v89, s41
  v_perm_b32 v44, v69, v65, s42
  v_perm_b32 v45, v77, v73, s42
  v_perm_b32 v46, v85, v81, s42
  v_perm_b32 v47, v93, v89, s42
  v_perm_b32 v48, v70, v66, s41
  v_perm_b32 v49, v78, v74, s41
  v_perm_b32 v50, v86, v82, s41
  v_perm_b32 v51, v94, v90, s41
  v_perm_b32 v52, v70, v66, s42
  v_perm_b32 v53, v78, v74, s42
  v_perm_b32 v54, v86, v82, s42
  v_perm_b32 v55, v94, v90, s42
  v_perm_b32 v56, v71, v67, s41
  v_perm_b32 v57, v79, v75, s41
  v_perm_b32 v58, v87, v83, s41
  v_perm_b32 v59, v95, v91, s41
  v_perm_b32 v60, v71, v67, s42
  v_perm_b32 v61, v79, v75, s42
  v_perm_b32 v62, v87, v83, s42
  v_perm_b32 v63, v95, v91, s42
  ds_write_b128 v24, v[32:35] offset:0
  ds_write_b128 v24, v[36:39] offset:16
  ds_write_b128 v24, v[40:43] offset:32
  ds_write_b128 v24, v[44:47] offset:48
  ds_write_b128 v24, v[48:51] offset:64
  ds_write_b128 v24, v[52:55] offset:80
  ds_write_b128 v24, v[56:59] offset:96
  ds_write_b128 v24, v[60:63] offset:112
  s_waitcnt lgkmcnt(0)
  s_waitcnt vmcnt(4)
  v_perm_b32 v32, v100, v96, s41
  v_perm_b32 v33, v108, v104, s41
  v_perm_b32 v34, v116, v112, s41
  v_perm_b32 v35, v124, v120, s41
  v_perm_b32 v36, v100, v96, s42
  v_perm_b32 v37, v108, v104, s42
  v_perm_b32 v38, v116, v112, s42
  v_perm_b32 v39, v124, v120, s42
  v_perm_b32 v40, v101, v97, s41
  v_perm_b32 v41, v109, v105, s41
  v_perm_b32 v42, v117, v113, s41
  v_perm_b32 v43, v125, v121, s41
  v_perm_b32 v44, v101, v97, s42
  v_perm_b32 v45, v109, v105, s42
  v_perm_b32 v46, v117, v113, s42
  v_perm_b32 v47, v125, v121, s42
  v_perm_b32 v48, v102, v98, s41
  v_perm_b32 v49, v110, v106, s41
  v_perm_b32 v50, v118, v114, s41
  v_perm_b32 v51, v126, v122, s41
  v_perm_b32 v52, v102, v98, s42
  v_perm_b32 v53, v110, v106, s42
  v_perm_b32 v54, v118, v114, s42
  v_perm_b32 v55, v126, v122, s42
  v_perm_b32 v56, v103, v99, s41
  v_perm_b32 v57, v111, v107, s41
  v_perm_b32 v58, v119, v115, s41
  v_perm_b32 v59, v127, v123, s41
  v_perm_b32 v60, v103, v99, s42
  v_perm_b32 v61, v111, v107, s42
  v_perm_b32 v62, v119, v115, s42
  v_perm_b32 v63, v127, v123, s42
  ds_write_b128 v24, v[32:35] offset:128
  ds_write_b128 v24, v[36:39] offset:144
  ds_write_b128 v24, v[40:43] offset:160
  ds_write_b128 v24, v[44:47] offset:176
  ds_write_b128 v24, v[48:51] offset:192
  ds_write_b128 v24, v[52:55] offset:208
  ds_write_b128 v24, v[56:59] offset:224
  ds_write_b128 v24, v[60:63] offset:240
  s_waitcnt lgkmcnt(0)
  s_branch sequential_preLN__gqa_block_cached__glu_gated_bilinear__decode_kernel_fill4
sequential_preLN__gqa_block_cached__glu_gated_bilinear__decode_kernel_rC:
sequential_preLN__gqa_block_cached__glu_gated_bilinear__decode_kernel_fill0:
  s_nop 1
  buffer_load_dwordx4 v[128:131], v4, s[16:19], s36 offen offset:0 nt
  buffer_load_dwordx4 v[132:135], v4, s[16:19], s36 offen offset:2048 nt
  buffer_load_dwordx4 v[136:139], v4, s[16:19], s37 offen offset:0 nt
  buffer_load_dwordx4 v[140:143], v4, s[16:19], s37 offen offset:2048 nt
sequential_preLN__gqa_block_cached__glu_gated_bilinear__decode_kernel_fill4:
  s_nop 1
  s_waitcnt vmcnt(4)
  buffer_load_dwordx4 v[144:147], v4, s[16:19], s38 offen offset:0 nt
  buffer_load_dwordx4 v[148:151], v4, s[16:19], s38 offen offset:2048 nt
  s_waitcnt vmcnt(4)
  buffer_load_dwordx4 v[152:155], v4, s[16:19], s39 offen offset:0 nt
  buffer_load_dwordx4 v[156:159], v4, s[16:19], s39 offen offset:2048 nt
  s_waitcnt vmcnt(4)
  buffer_load_dwordx4 v[160:163], v4, s[16:19], s36 offen offset:256 nt
  buffer_load_dwordx4 v[164:167], v4, s[16:19], s36 offen offset:2304 nt
  s_waitcnt vmcnt(4)
  buffer_load_dwordx4 v[168:171], v4, s[16:19], s37 offen offset:256 nt
  buffer_load_dwordx4 v[172:175], v4, s[16:19], s37 offen offset:2304 nt
  s_waitcnt vmcnt(4)
  buffer_load_dwordx4 v[176:179], v4, s[16:19], s38 offen offset:256 nt
  buffer_load_dwordx4 v[180:183], v4, s[16:19], s38 offen offset:2304 nt
  s_waitcnt vmcnt(4)
  buffer_load_dwordx4 v[184:187], v4, s[16:19], s39 offen offset:256 nt
  buffer_load_dwordx4 v[188:191], v4, s[16:19], s39 offen offset:2304 nt
  s_waitcnt vmcnt(4)
  buffer_load_dwordx4 v[192:195], v5, s[20:23], s8 offen offset:0 nt
  buffer_load_dwordx4 v[196:199], v5, s[20:23], s8 offen offset:2048 nt
  s_waitcnt vmcnt(4)
  buffer_load_dwordx4 v[200:203], v5, s[20:23], s9 offen offset:0 nt
  buffer_load_dwordx4 v[204:207], v5, s[20:23], s9 offen offset:2048 nt
  s_waitcnt vmcnt(4)
  buffer_load_dwordx4 v[208:211], v5, s[20:23], s10 offen offset:0 nt
  buffer_load_dwordx4 v[212:215], v5, s[20:23], s10 offen offset:2048 nt
  s_waitcnt vmcnt(4)
  buffer_load_dwordx4 v[216:219], v5, s[20:23], s11 offen offset:0 nt
  buffer_load_dwordx4 v[220:223], v5, s[20:23], s11 offen offset:2048 nt
  s_waitcnt vmcnt(4)
  buffer_load_dwordx4 v[224:227], v5, s[20:23], s8 offen offset:256 nt
  buffer_load_dwordx4 v[228:231], v5, s[20:23], s8 offen offset:2304 nt
  s_waitcnt vmcnt(4)
  buffer_load_dwordx4 v[232:235], v5, s[20:23], s9 offen offset:256 nt
  buffer_load_dwordx4 v[236:239], v5, s[20:23], s9 offen offset:2304 nt
  s_waitcnt vmcnt(4)
  buffer_load_dwordx4 v[240:243], v5, s[20:23], s10 offen offset:256 nt
  buffer_load_dwordx4 v[244:247], v5, s[20:23], s10 offen offset:2304 nt
  s_waitcnt vmcnt(4)
  buffer_load_dwordx4 v[248:251], v5, s[20:23], s11 offen offset:256 nt
  buffer_load_dwordx4 v[252:255], v5, s[20:23], s11 offen offset:2304 nt
  s_waitcnt vmcnt(4)
  buffer_load_dwordx4 v[64:67], v4, s[16:19], s8 offen offset:0 nt
  buffer_load_dwordx4 v[68:71], v4, s[16:19], s8 offen offset:2048 nt
  s_waitcnt vmcnt(4)
  buffer_load_dwordx4 v[72:75], v4, s[16:19], s9 offen offset:0 nt
  buffer_load_dwordx4 v[76:79], v4, s[16:19], s9 offen offset:2048 nt
  s_waitcnt vmcnt(4)
  buffer_load_dwordx4 v[80:83], v4, s[16:19], s10 offen offset:0 nt
  buffer_load_dwordx4 v[84:87], v4, s[16:19], s10 offen offset:2048 nt
  s_waitcnt vmcnt(4)
  buffer_load_dwordx4 v[88:91], v4, s[16:19], s11 offen offset:0 nt
  buffer_load_dwordx4 v[92:95], v4, s[16:19], s11 offen offset:2048 nt
  s_waitcnt vmcnt(4)
  buffer_load_dwordx4 v[96:99], v4, s[16:19], s8 offen offset:256 nt
  buffer_load_dwordx4 v[100:103], v4, s[16:19], s8 offen offset:2304 nt
  s_waitcnt vmcnt(4)
  buffer_load_dwordx4 v[104:107], v4, s[16:19], s9 offen offset:256 nt
  buffer_load_dwordx4 v[108:111], v4, s[16:19], s9 offen offset:2304 nt
  s_waitcnt vmcnt(4)
  buffer_load_dwordx4 v[112:115], v4, s[16:19], s10 offen offset:256 nt
  buffer_load_dwordx4 v[116:119], v4, s[16:19], s10 offen offset:2304 nt
  s_waitcnt vmcnt(4)
  buffer_load_dwordx4 v[120:123], v4, s[16:19], s11 offen offset:256 nt
  buffer_load_dwordx4 v[124:127], v4, s[16:19], s11 offen offset:2304 nt
  v_mov_b32 v13, 0
  s_waitcnt lgkmcnt(0)
  s_add_u32 s62, s82, 1
  s_addc_u32 s63, s83, 0
  s_lshr_b64 s[100:101], s[62:63], 16
  s_lshl_b32 s101, s62, 16
sequential_preLN__gqa_block_cached__glu_gated_bilinear__decode_kernel_qwait:
  ds_read_b32 v12, v13 offset:1156
  s_waitcnt lgkmcnt(0)
  v_readfirstlane_b32 s51, v12
  s_nop 0
  s_cmp_eq_u32 s51, 1
  s_cbranch_scc1 sequential_preLN__gqa_block_cached__glu_gated_bilinear__decode_kernel_join
  s_cmp_eq_u32 s80, 0
  s_cbranch_scc1 sequential_preLN__gqa_block_cached__glu_gated_bilinear__decode_kernel_join
  s_sub_u32 s80, s80, 1
  s_sleep 2
  s_branch sequential_preLN__gqa_block_cached__glu_gated_bilinear__decode_kernel_qwait
sequential_preLN__gqa_block_cached__glu_gated_bilinear__decode_kernel_join:
  s_nop 7
  v_and_b32 v7, 1, v2
  v_lshlrev_b32 v7, 9, v7
  v_bfe_u32 v8, v2, 1, 2
  v_lshl_add_u32 v7, v8, 6, v7
  v_lshl_add_u32 v7, v3, 4, v7
  s_waitcnt lgkmcnt(0)
  ds_read_b128 v[16:19], v7 offset:0
  ds_read_b128 v[20:23], v7 offset:256
  v_mov_b32 v8, 0xff7fffff
  v_mov_b32 v9, 0
  s_add_u32 s51, s97, 64
  v_mov_b32 v10, s51
  v_mov_b32 v11, 0
  s_mov_b32 s88, 0
  s_mov_b32 s87, 32
  s_cmp_ge_u32 s72, 3
  s_cselect_b32 s86, 100000, -1
  s_waitcnt vmcnt(0) lgkmcnt(0)
  v_mfma_f32_16x16x32_bf16 v[32:35], v[64:67], v[16:19], 0
  v_mfma_f32_16x16x32_bf16 v[36:39], v[68:71], v[16:19], 0
  v_mfma_f32_16x16x32_bf16 v[40:43], v[72:75], v[16:19], 0
  v_mfma_f32_16x16x32_bf16 v[44:47], v[76:79], v[16:19], 0
  v_mfma_f32_16x16x32_bf16 v[48:51], v[80:83], v[16:19], 0
  v_mfma_f32_16x16x32_bf16 v[52:55], v[84:87], v[16:19], 0
  v_mfma_f32_16x16x32_bf16 v[56:59], v[88:91], v[16:19], 0
  v_mfma_f32_16x16x32_bf16 v[60:63], v[92:95], v[16:19], 0
  v_mfma_f32_16x16x32_bf16 v[32:35], v[96:99], v[20:23], v[32:35]
  v_mfma_f32_16x16x32_bf16 v[36:39], v[100:103], v[20:23], v[36:39]
  v_mfma_f32_16x16x32_bf16 v[40:43], v[104:107], v[20:23], v[40:43]
  v_mfma_f32_16x16x32_bf16 v[44:47], v[108:111], v[20:23], v[44:47]
  v_mfma_f32_16x16x32_bf16 v[48:51], v[112:115], v[20:23], v[48:51]
  v_mfma_f32_16x16x32_bf16 v[52:55], v[116:119], v[20:23], v[52:55]
  v_mfma_f32_16x16x32_bf16 v[56:59], v[120:123], v[20:23], v[56:59]
  v_mfma_f32_16x16x32_bf16 v[60:63], v[124:127], v[20:23], v[60:63]
  v_mov_b32 v64, 0
  v_mov_b32 v65, 0
  v_mov_b32 v66, 0
  v_mov_b32 v67, 0
  v_mov_b32 v68, 0
  v_mov_b32 v69, 0
  v_mov_b32 v70, 0
  v_mov_b32 v71, 0
  v_mov_b32 v72, 0
  v_mov_b32 v73, 0
  v_mov_b32 v74, 0
  v_mov_b32 v75, 0
  v_mov_b32 v76, 0
  v_mov_b32 v77, 0
  v_mov_b32 v78, 0
  v_mov_b32 v79, 0
  v_mov_b32 v80, 0
  v_mov_b32 v81, 0
  v_mov_b32 v82, 0
  v_mov_b32 v83, 0
  v_mov_b32 v84, 0
  v_mov_b32 v85, 0
  v_mov_b32 v86, 0
  v_mov_b32 v87, 0
  v_mov_b32 v88, 0
  v_mov_b32 v89, 0
  v_mov_b32 v90, 0
  v_mov_b32 v91, 0
  v_mov_b32 v92, 0
  v_mov_b32 v93, 0
  v_mov_b32 v94, 0
  v_mov_b32 v95, 0
  v_mov_b32 v96, 0
  v_mov_b32 v97, 0
  v_mov_b32 v98, 0
  v_mov_b32 v99, 0
  v_mov_b32 v100, 0
  v_mov_b32 v101, 0
  v_mov_b32 v102, 0
  v_mov_b32 v103, 0
  v_mov_b32 v104, 0
  v_mov_b32 v105, 0
  v_mov_b32 v106, 0
  v_mov_b32 v107, 0
  v_mov_b32 v108, 0
  v_mov_b32 v109, 0
  v_mov_b32 v110, 0
  v_mov_b32 v111, 0
  v_mov_b32 v112, 0
  v_mov_b32 v113, 0
  v_mov_b32 v114, 0
  v_mov_b32 v115, 0
  v_mov_b32 v116, 0
  v_mov_b32 v117, 0
  v_mov_b32 v118, 0
  v_mov_b32 v119, 0
  v_mov_b32 v120, 0
  v_mov_b32 v121, 0
  v_mov_b32 v122, 0
  v_mov_b32 v123, 0
  v_mov_b32 v124, 0
  v_mov_b32 v125, 0
  v_mov_b32 v126, 0
  v_mov_b32 v127, 0
  v_add_f32_dpp v32, v33, v32 row_shl:2 row_mask:0xf bank_mask:0xf
  v_add_f32_dpp v34, v35, v34 row_shl:2 row_mask:0xf bank_mask:0xf
  v_add_f32_dpp v36, v37, v36 row_shl:2 row_mask:0xf bank_mask:0xf
  v_add_f32_dpp v38, v39, v38 row_shl:2 row_mask:0xf bank_mask:0xf
  v_add_f32_dpp v40, v41, v40 row_shl:2 row_mask:0xf bank_mask:0xf
  v_add_f32_dpp v42, v43, v42 row_shl:2 row_mask:0xf bank_mask:0xf
  v_add_f32_dpp v44, v45, v44 row_shl:2 row_mask:0xf bank_mask:0xf
  v_add_f32_dpp v46, v47, v46 row_shl:2 row_mask:0xf bank_mask:0xf
  v_add_f32_dpp v48, v49, v48 row_shl:2 row_mask:0xf bank_mask:0xf
  v_add_f32_dpp v50, v51, v50 row_shl:2 row_mask:0xf bank_mask:0xf
  v_add_f32_dpp v52, v53, v52 row_shl:2 row_mask:0xf bank_mask:0xf
  v_add_f32_dpp v54, v55, v54 row_shl:2 row_mask:0xf bank_mask:0xf
  v_add_f32_dpp v56, v57, v56 row_shl:2 row_mask:0xf bank_mask:0xf
  v_add_f32_dpp v58, v59, v58 row_shl:2 row_mask:0xf bank_mask:0xf
  v_add_f32_dpp v60, v61, v60 row_shl:2 row_mask:0xf bank_mask:0xf
  v_add_f32_dpp v62, v63, v62 row_shl:2 row_mask:0xf bank_mask:0xf
  v_add_f32_dpp v24, v34, v32 row_shl:4 row_mask:0xf bank_mask:0xf
  v_add_f32_dpp v25, v38, v36 row_shl:4 row_mask:0xf bank_mask:0xf
  v_add_f32_dpp v26, v42, v40 row_shl:4 row_mask:0xf bank_mask:0xf
  v_add_f32_dpp v27, v46, v44 row_shl:4 row_mask:0xf bank_mask:0xf
  v_add_f32_dpp v28, v50, v48 row_shl:4 row_mask:0xf bank_mask:0xf
  v_add_f32_dpp v29, v54, v52 row_shl:4 row_mask:0xf bank_mask:0xf
  v_add_f32_dpp v30, v58, v56 row_shl:4 row_mask:0xf bank_mask:0xf
  v_add_f32_dpp v31, v62, v60 row_shl:4 row_mask:0xf bank_mask:0xf
  v_cvt_pk_bf16_f32 v7, v24, v25
  v_lshlrev_b32 v24, 16, v7
  v_and_b32 v25, s44, v7
  v_cvt_pk_bf16_f32 v7, v26, v27
  v_lshlrev_b32 v26, 16, v7
  v_and_b32 v27, s44, v7
  v_cvt_pk_bf16_f32 v7, v28, v29
  v_lshlrev_b32 v28, 16, v7
  v_and_b32 v29, s44, v7
  v_cvt_pk_bf16_f32 v7, v30, v31
  v_lshlrev_b32 v30, 16, v7
  v_and_b32 v31, s44, v7
sequential_preLN__gqa_block_cached__glu_gated_bilinear__decode_kernel_loop:
  s_waitcnt vmcnt(8)
  v_readfirstlane_b32 s99, v10
  s_nop 0
  s_cmp_ge_u32 s99, 256
  s_cbranch_scc1 sequential_preLN__gqa_block_cached__glu_gated_bilinear__decode_kernel_loopC
  s_cmp_ge_u32 s99, 100000
  s_cbranch_scc1 sequential_preLN__gqa_block_cached__glu_gated_bilinear__decode_kernel_loopB
  s_mov_b32 s4, s36
  s_cmp_lt_u32 s36, 0x400000
  s_cselect_b32 s12, 0, 0xff7fffff
  s_mov_b32 s5, s37
  s_cmp_lt_u32 s37, 0x400000
  s_cselect_b32 s13, 0, 0xff7fffff
  s_mov_b32 s6, s38
  s_cmp_lt_u32 s38, 0x400000
  s_cselect_b32 s14, 0, 0xff7fffff
  s_mov_b32 s7, s39
  s_cmp_lt_u32 s39, 0x400000
  s_cselect_b32 s15, 0, 0xff7fffff
  s_mov_b32 s51, s99
  s_mov_b32 s52, 15
  s_sub_u32 s53, s99, 256
  s_lshr_b32 s54, s53, 1
  s_add_u32 s54, s54, 256
  s_and_b32 s55, s53, 1
  s_lshl_b32 s55, s55, 1
  s_lshl_b32 s55, 3, s55
  s_cmp_ge_u32 s99, 256
  s_cselect_b32 s51, s54, s51
  s_cselect_b32 s52, s55, s52
  s_sub_u32 s53, s99, 256
  s_lshr_b32 s54, s53, 2
  s_add_u32 s54, s54, 256
  s_and_b32 s55, s53, 3
  s_lshl_b32 s55, 1, s55
  s_cmp_ge_u32 s99, 256
  s_cselect_b32 s51, s54, s51
  s_cselect_b32 s52, s55, s52
  s_cmp_ge_u32 s99, 256
  s_cselect_b32 s52, 0, s52
  s_add_u32 s51, s51, s84
  s_and_b32 s51, s51, 255
  s_lshl_b32 s51, s51, 14
  s_bitcmp1_b32 s52, 0
  s_cselect_b32 s36, s51, 0x400000
  s_add_u32 s51, s51, 4096
  s_bitcmp1_b32 s52, 1
  s_cselect_b32 s37, s51, 0x400000
  s_add_u32 s51, s51, 4096
  s_bitcmp1_b32 s52, 2
  s_cselect_b32 s38, s51, 0x400000
  s_add_u32 s51, s51, 4096
  s_bitcmp1_b32 s52, 3
  s_cselect_b32 s39, s51, 0x400000
  s_add_u32 s51, s51, 4096
  v_mfma_f32_16x16x32_bf16 v[32:35], v[128:131], v[16:19], 0
  v_mfma_f32_16x16x32_bf16 v[36:39], v[132:135], v[16:19], 0
  v_mfma_f32_16x16x32_bf16 v[40:43], v[136:139], v[16:19], 0
  v_mfma_f32_16x16x32_bf16 v[44:47], v[140:143], v[16:19], 0
  v_mfma_f32_16x16x32_bf16 v[48:51], v[144:147], v[16:19], 0
  v_mfma_f32_16x16x32_bf16 v[52:55], v[148:151], v[16:19], 0
  v_mfma_f32_16x16x32_bf16 v[56:59], v[152:155], v[16:19], 0
  v_mfma_f32_16x16x32_bf16 v[60:63], v[156:159], v[16:19], 0
  v_mfma_f32_16x16x32_bf16 v[32:35], v[160:163], v[20:23], v[32:35]
  s_waitcnt vmcnt(4)
  buffer_load_dwordx4 v[128:131], v4, s[16:19], s36 offen offset:0 nt
  buffer_load_dwordx4 v[132:135], v4, s[16:19], s36 offen offset:2048 nt
  v_mfma_f32_16x16x32_bf16 v[36:39], v[164:167], v[20:23], v[36:39]
  v_mfma_f32_16x16x32_bf16 v[40:43], v[168:171], v[20:23], v[40:43]
  v_mfma_f32_16x16x32_bf16 v[44:47], v[172:175], v[20:23], v[44:47]
  v_mfma_f32_16x16x32_bf16 v[48:51], v[176:179], v[20:23], v[48:51]
  v_mfma_f32_16x16x32_bf16 v[52:55], v[180:183], v[20:23], v[52:55]
  v_mfma_f32_16x16x32_bf16 v[56:59], v[184:187], v[20:23], v[56:59]
  v_mfma_f32_16x16x32_bf16 v[60:63], v[188:191], v[20:23], v[60:63]
  v_max3_f32 v6, v24, v25, v26
  v_max3_f32 v6, v6, v27, v28
  v_max3_f32 v6, v6, v29, v30
  v_max3_f32 v6, v6, v31, v8
  v_mov_b32 v7, v6
  s_nop 1
  v_permlane16_swap_b32 v6, v7
  v_max_f32 v6, v6, v7
  v_mov_b32 v7, v6
  s_nop 1
  v_permlane32_swap_b32 v6, v7
  v_max_f32 v6, v6, v7
  v_cmp_gt_f32 vcc, v6, v8
  v_sub_f32 v7, v8, v6
  s_waitcnt vmcnt(4)
  buffer_load_dwordx4 v[136:139], v4, s[16:19], s37 offen offset:0 nt
  buffer_load_dwordx4 v[140:143], v4, s[16:19], s37 offen offset:2048 nt
  v_mul_f32 v7, s45, v7
  v_exp_f32 v7, v7
  v_mov_b32 v8, v6
  v_mul_f32 v6, s45, v6
  s_and_b32 s51, vcc_lo, 3
  s_cbranch_scc0 sequential_preLN__gqa_block_cached__glu_gated_bilinear__decode_kernel_norescaleA
  v_mul_f32 v9, v9, v7
  v_readlane_b32 s51, v7, 0
  v_readlane_b32 s52, v7, 1
  s_nop 1
  v_mul_f32 v64, s51, v64
  v_mul_f32 v65, s52, v65
  v_mul_f32 v68, s51, v68
  v_mul_f32 v69, s52, v69
  v_mul_f32 v72, s51, v72
  v_mul_f32 v73, s52, v73
  v_mul_f32 v76, s51, v76
  v_mul_f32 v77, s52, v77
  v_mul_f32 v80, s51, v80
  v_mul_f32 v81, s52, v81
  v_mul_f32 v84, s51, v84
  v_mul_f32 v85, s52, v85
  v_mul_f32 v88, s51, v88
  v_mul_f32 v89, s52, v89
  v_mul_f32 v92, s51, v92
  v_mul_f32 v93, s52, v93
  v_mul_f32 v96, s51, v96
  v_mul_f32 v97, s52, v97
  v_mul_f32 v100, s51, v100
  v_mul_f32 v101, s52, v101
  v_mul_f32 v104, s51, v104
  v_mul_f32 v105, s52, v105
  v_mul_f32 v108, s51, v108
  v_mul_f32 v109, s52, v109
  v_mul_f32 v112, s51, v112
  v_mul_f32 v113, s52, v113
  v_mul_f32 v116, s51, v116
  v_mul_f32 v117, s52, v117
  v_mul_f32 v120, s51, v120
  v_mul_f32 v121, s52, v121
  v_mul_f32 v124, s51, v124
  v_mul_f32 v125, s52, v125
sequential_preLN__gqa_block_cached__glu_gated_bilinear__decode_kernel_norescaleA:
  v_fma_f32 v24, v24, s45, -v6
  s_waitcnt vmcnt(4)
  buffer_load_dwordx4 v[144:147], v4, s[16:19], s38 offen offset:0 nt
  buffer_load_dwordx4 v[148:151], v4, s[16:19], s38 offen offset:2048 nt
  v_fma_f32 v25, v25, s45, -v6
  v_fma_f32 v26, v26, s45, -v6
  v_fma_f32 v27, v27, s45, -v6
  v_fma_f32 v28, v28, s45, -v6
  v_fma_f32 v29, v29, s45, -v6
  v_fma_f32 v30, v30, s45, -v6
  v_fma_f32 v31, v31, s45, -v6
  v_exp_f32 v24, v24
  v_exp_f32 v25, v25
  v_exp_f32 v26, v26
  v_exp_f32 v27, v27
  v_exp_f32 v28, v28
  v_exp_f32 v29, v29
  v_exp_f32 v30, v30
  v_exp_f32 v31, v31
  v_add_f32 v7, v24, v25
  v_cvt_pk_bf16_f32 v12, v24, v25
  v_add_f32 v9, v9, v7
  v_add_f32 v7, v26, v27
  s_waitcnt vmcnt(4)
  buffer_load_dwordx4 v[152:155], v4, s[16:19], s39 offen offset:0 nt
  buffer_load_dwordx4 v[156:159], v4, s[16:19], s39 offen offset:2048 nt
  v_cvt_pk_bf16_f32 v13, v26, v27
  v_add_f32 v9, v9, v7
  v_add_f32 v7, v28, v29
  v_cvt_pk_bf16_f32 v14, v28, v29
  v_add_f32 v9, v9, v7
  v_add_f32 v7, v30, v31
  v_cvt_pk_bf16_f32 v15, v30, v31
  v_add_f32 v9, v9, v7
  v_add_f32_dpp v32, v33, v32 row_shl:2 row_mask:0xf bank_mask:0xf
  v_add_f32_dpp v34, v35, v34 row_shl:2 row_mask:0xf bank_mask:0xf
  v_add_f32_dpp v36, v37, v36 row_shl:2 row_mask:0xf bank_mask:0xf
  v_add_f32_dpp v38, v39, v38 row_shl:2 row_mask:0xf bank_mask:0xf
  v_add_f32_dpp v40, v41, v40 row_shl:2 row_mask:0xf bank_mask:0xf
  v_add_f32_dpp v42, v43, v42 row_shl:2 row_mask:0xf bank_mask:0xf
  v_add_f32_dpp v44, v45, v44 row_shl:2 row_mask:0xf bank_mask:0xf
  v_add_f32_dpp v46, v47, v46 row_shl:2 row_mask:0xf bank_mask:0xf
  v_add_f32_dpp v48, v49, v48 row_shl:2 row_mask:0xf bank_mask:0xf
  v_add_f32_dpp v50, v51, v50 row_shl:2 row_mask:0xf bank_mask:0xf
  v_add_f32_dpp v52, v53, v52 row_shl:2 row_mask:0xf bank_mask:0xf
  s_waitcnt vmcnt(4)
  buffer_load_dwordx4 v[160:163], v4, s[16:19], s36 offen offset:256 nt
  buffer_load_dwordx4 v[164:167], v4, s[16:19], s36 offen offset:2304 nt
  v_add_f32_dpp v54, v55, v54 row_shl:2 row_mask:0xf bank_mask:0xf
  v_add_f32_dpp v56, v57, v56 row_shl:2 row_mask:0xf bank_mask:0xf
  v_add_f32_dpp v58, v59, v58 row_shl:2 row_mask:0xf bank_mask:0xf
  v_add_f32_dpp v60, v61, v60 row_shl:2 row_mask:0xf bank_mask:0xf
  v_add_f32_dpp v62, v63, v62 row_shl:2 row_mask:0xf bank_mask:0xf
  v_add_f32_dpp v24, v34, v32 row_shl:4 row_mask:0xf bank_mask:0xf
  v_add_f32_dpp v25, v38, v36 row_shl:4 row_mask:0xf bank_mask:0xf
  v_add_f32_dpp v26, v42, v40 row_shl:4 row_mask:0xf bank_mask:0xf
  v_add_f32_dpp v27, v46, v44 row_shl:4 row_mask:0xf bank_mask:0xf
  v_add_f32_dpp v28, v50, v48 row_shl:4 row_mask:0xf bank_mask:0xf
  v_add_f32_dpp v29, v54, v52 row_shl:4 row_mask:0xf bank_mask:0xf
  v_add_f32_dpp v30, v58, v56 row_shl:4 row_mask:0xf bank_mask:0xf
  v_add_f32_dpp v31, v62, v60 row_shl:4 row_mask:0xf bank_mask:0xf
  v_cvt_pk_bf16_f32 v7, v24, v25
  v_lshlrev_b32 v24, 16, v7
  v_and_b32 v25, s44, v7
  v_add_f32 v24, s12, v24
  v_add_f32 v25, s12, v25
  v_cvt_pk_bf16_f32 v7, v26, v27
  s_waitcnt vmcnt(4)
  buffer_load_dwordx4 v[168:171], v4, s[16:19], s37 offen offset:256 nt
  buffer_load_dwordx4 v[172:175], v4, s[16:19], s37 offen offset:2304 nt
  v_lshlrev_b32 v26, 16, v7
  v_and_b32 v27, s44, v7
  v_add_f32 v26, s13, v26
  v_add_f32 v27, s13, v27
  v_cvt_pk_bf16_f32 v7, v28, v29
  v_lshlrev_b32 v28, 16, v7
  v_and_b32 v29, s44, v7
  v_add_f32 v28, s14, v28
  v_add_f32 v29, s14, v29
  v_cvt_pk_bf16_f32 v7, v30, v31
  v_lshlrev_b32 v30, 16, v7
  v_and_b32 v31, s44, v7
  v_add_f32 v30, s15, v30
  v_add_f32 v31, s15, v31
  v_perm_b32 v32, v196, v192, s41
  v_perm_b32 v33, v204, v200, s41
  v_perm_b32 v34, v212, v208, s41
  v_perm_b32 v35, v220, v216, s41
  v_perm_b32 v36, v196, v192, s42
  s_waitcnt vmcnt(4)
  buffer_load_dwordx4 v[176:179], v4, s[16:19], s38 offen offset:256 nt
  buffer_load_dwordx4 v[180:183], v4, s[16:19], s38 offen offset:2304 nt
  v_perm_b32 v37, v204, v200, s42
  v_perm_b32 v38, v212, v208, s42
  v_perm_b32 v39, v220, v216, s42
  v_mfma_f32_16x16x32_bf16 v[64:67], v[12:15], v[32:35], v[64:67]
  v_perm_b32 v40, v197, v193, s41
  v_perm_b32 v41, v205, v201, s41
  v_perm_b32 v42, v213, v209, s41
  v_perm_b32 v43, v221, v217, s41
  v_mfma_f32_16x16x32_bf16 v[68:71], v[12:15], v[36:39], v[68:71]
  v_perm_b32 v32, v197, v193, s42
  v_perm_b32 v33, v205, v201, s42
  v_perm_b32 v34, v213, v209, s42
  v_perm_b32 v35, v221, v217, s42
  v_mfma_f32_16x16x32_bf16 v[72:75], v[12:15], v[40:43], v[72:75]
  v_perm_b32 v36, v198, v194, s41
  v_perm_b32 v37, v206, v202, s41
  v_perm_b32 v38, v214, v210, s41
  v_perm_b32 v39, v222, v218, s41
  v_mfma_f32_16x16x32_bf16 v[76:79], v[12:15], v[32:35], v[76:79]
  s_waitcnt vmcnt(4)
  buffer_load_dwordx4 v[184:187], v4, s[16:19], s39 offen offset:256 nt
  buffer_load_dwordx4 v[188:191], v4, s[16:19], s39 offen offset:2304 nt
  v_perm_b32 v40, v198, v194, s42
  v_perm_b32 v41, v206, v202, s42
  v_perm_b32 v42, v214, v210, s42
  v_perm_b32 v43, v222, v218, s42
  v_mfma_f32_16x16x32_bf16 v[80:83], v[12:15], v[36:39], v[80:83]
  v_perm_b32 v32, v199, v195, s41
  v_perm_b32 v33, v207, v203, s41
  v_perm_b32 v34, v215, v211, s41
  v_perm_b32 v35, v223, v219, s41
  v_mfma_f32_16x16x32_bf16 v[84:87], v[12:15], v[40:43], v[84:87]
  v_perm_b32 v36, v199, v195, s42
  v_perm_b32 v37, v207, v203, s42
  v_perm_b32 v38, v215, v211, s42
  v_perm_b32 v39, v223, v219, s42
  v_mfma_f32_16x16x32_bf16 v[88:91], v[12:15], v[32:35], v[88:91]
  s_nop 0
  v_mfma_f32_16x16x32_bf16 v[92:95], v[12:15], v[36:39], v[92:95]
  s_waitcnt vmcnt(16)
  v_perm_b32 v32, v228, v224, s41
  v_perm_b32 v33, v236, v232, s41
  v_perm_b32 v34, v244, v240, s41
  s_waitcnt vmcnt(4)
  buffer_load_dwordx4 v[192:195], v5, s[20:23], s4 offen offset:0 nt
  buffer_load_dwordx4 v[196:199], v5, s[20:23], s4 offen offset:2048 nt
  v_perm_b32 v35, v252, v248, s41
  v_perm_b32 v36, v228, v224, s42
  v_perm_b32 v37, v236, v232, s42
  v_perm_b32 v38, v244, v240, s42
  v_perm_b32 v39, v252, v248, s42
  v_mfma_f32_16x16x32_bf16 v[96:99], v[12:15], v[32:35], v[96:99]
  v_perm_b32 v40, v229, v225, s41
  v_perm_b32 v41, v237, v233, s41
  v_perm_b32 v42, v245, v241, s41
  v_perm_b32 v43, v253, v249, s41
  v_mfma_f32_16x16x32_bf16 v[100:103], v[12:15], v[36:39], v[100:103]
  v_perm_b32 v32, v229, v225, s42
  v_perm_b32 v33, v237, v233, s42
  v_perm_b32 v34, v245, v241, s42
  v_perm_b32 v35, v253, v249, s42
  v_mfma_f32_16x16x32_bf16 v[104:107], v[12:15], v[40:43], v[104:107]
  v_perm_b32 v36, v230, v226, s41
  v_perm_b32 v37, v238, v234, s41
  v_perm_b32 v38, v246, v242, s41
  s_waitcnt vmcnt(4)
  buffer_load_dwordx4 v[200:203], v5, s[20:23], s5 offen offset:0 nt
  buffer_load_dwordx4 v[204:207], v5, s[20:23], s5 offen offset:2048 nt
  v_perm_b32 v39, v254, v250, s41
  v_mfma_f32_16x16x32_bf16 v[108:111], v[12:15], v[32:35], v[108:111]
  v_perm_b32 v40, v230, v226, s42
  v_perm_b32 v41, v238, v234, s42
  v_perm_b32 v42, v246, v242, s42
  v_perm_b32 v43, v254, v250, s42
  v_mfma_f32_16x16x32_bf16 v[112:115], v[12:15], v[36:39], v[112:115]
  v_perm_b32 v32, v231, v227, s41
  v_perm_b32 v33, v239, v235, s41
  v_perm_b32 v34, v247, v243, s41
  v_perm_b32 v35, v255, v251, s41
  v_mfma_f32_16x16x32_bf16 v[116:119], v[12:15], v[40:43], v[116:119]
  v_perm_b32 v36, v231, v227, s42
  v_perm_b32 v37, v239, v235, s42
  v_perm_b32 v38, v247, v243, s42
  v_perm_b32 v39, v255, v251, s42
  v_mfma_f32_16x16x32_bf16 v[120:123], v[12:15], v[32:35], v[120:123]
  s_nop 0
  v_mfma_f32_16x16x32_bf16 v[124:127], v[12:15], v[36:39], v[124:127]
  s_waitcnt vmcnt(4)
  buffer_load_dwordx4 v[208:211], v5, s[20:23], s6 offen offset:0 nt
  buffer_load_dwordx4 v[212:215], v5, s[20:23], s6 offen offset:2048 nt
  s_waitcnt vmcnt(4)
  buffer_load_dwordx4 v[216:219], v5, s[20:23], s7 offen offset:0 nt
  buffer_load_dwordx4 v[220:223], v5, s[20:23], s7 offen offset:2048 nt
  s_waitcnt vmcnt(4)
  v_mov_b32 v10, 256
  s_cmp_lt_u32 s99, s86
  s_cselect_b64 exec, 1, 0
  v_mov_b32 v10, 1
  buffer_atomic_add v10, v11, s[32:35], s98 offen sc0 sc1
  s_mov_b64 exec, -1
  buffer_load_dwordx4 v[224:227], v5, s[20:23], s4 offen offset:256 nt
  s_waitcnt vmcnt(4)
  buffer_load_dwordx4 v[228:231], v5, s[20:23], s4 offen offset:2304 nt
  buffer_load_dwordx4 v[232:235], v5, s[20:23], s5 offen offset:256 nt
  s_waitcnt vmcnt(4)
  buffer_load_dwordx4 v[236:239], v5, s[20:23], s5 offen offset:2304 nt
  buffer_load_dwordx4 v[240:243], v5, s[20:23], s6 offen offset:256 nt
  s_waitcnt vmcnt(4)
  buffer_load_dwordx4 v[244:247], v5, s[20:23], s6 offen offset:2304 nt
  buffer_load_dwordx4 v[248:251], v5, s[20:23], s7 offen offset:256 nt
  s_waitcnt vmcnt(4)
  buffer_load_dwordx4 v[252:255], v5, s[20:23], s7 offen offset:2304 nt
  s_nop 7
  s_branch sequential_preLN__gqa_block_cached__glu_gated_bilinear__decode_kernel_loop
sequential_preLN__gqa_block_cached__glu_gated_bilinear__decode_kernel_loopB:
  s_nop 1
  s_mov_b32 s4, s36
  s_cmp_lt_u32 s36, 0x400000
  s_cselect_b32 s12, 0, 0xff7fffff
  s_mov_b32 s5, s37
  s_cmp_lt_u32 s37, 0x400000
  s_cselect_b32 s13, 0, 0xff7fffff
  s_mov_b32 s6, s38
  s_cmp_lt_u32 s38, 0x400000
  s_cselect_b32 s14, 0, 0xff7fffff
  s_mov_b32 s7, s39
  s_cmp_lt_u32 s39, 0x400000
  s_cselect_b32 s15, 0, 0xff7fffff
  s_mov_b32 s51, s99
  s_mov_b32 s52, 15
  s_sub_u32 s53, s99, 256
  s_lshr_b32 s54, s53, 1
  s_add_u32 s54, s54, 256
  s_and_b32 s55, s53, 1
  s_lshl_b32 s55, s55, 1
  s_lshl_b32 s55, 3, s55
  s_cmp_ge_u32 s99, 256
  s_cselect_b32 s51, s54, s51
  s_cselect_b32 s52, s55, s52
  s_sub_u32 s53, s99, 256
  s_lshr_b32 s54, s53, 2
  s_add_u32 s54, s54, 256
  s_and_b32 s55, s53, 3
  s_lshl_b32 s55, 1, s55
  s_cmp_ge_u32 s99, 256
  s_cselect_b32 s51, s54, s51
  s_cselect_b32 s52, s55, s52
  s_cmp_ge_u32 s99, 256
  s_cselect_b32 s52, 0, s52
  s_add_u32 s51, s51, s84
  s_and_b32 s51, s51, 255
  s_lshl_b32 s51, s51, 14
  s_bitcmp1_b32 s52, 0
  s_cselect_b32 s36, s51, 0x400000
  s_add_u32 s51, s51, 4096
  s_bitcmp1_b32 s52, 1
  s_cselect_b32 s37, s51, 0x400000
  s_add_u32 s51, s51, 4096
  s_bitcmp1_b32 s52, 2
  s_cselect_b32 s38, s51, 0x400000
  s_add_u32 s51, s51, 4096
  s_bitcmp1_b32 s52, 3
  s_cselect_b32 s39, s51, 0x400000
  s_add_u32 s51, s51, 4096
  v_mfma_f32_16x16x32_bf16 v[32:35], v[128:131], v[16:19], 0
  v_mfma_f32_16x16x32_bf16 v[36:39], v[132:135], v[16:19], 0
  v_mfma_f32_16x16x32_bf16 v[40:43], v[136:139], v[16:19], 0
  v_mfma_f32_16x16x32_bf16 v[44:47], v[140:143], v[16:19], 0
  v_mfma_f32_16x16x32_bf16 v[48:51], v[144:147], v[16:19], 0
  v_mfma_f32_16x16x32_bf16 v[52:55], v[148:151], v[16:19], 0
  v_mfma_f32_16x16x32_bf16 v[56:59], v[152:155], v[16:19], 0
  v_mfma_f32_16x16x32_bf16 v[60:63], v[156:159], v[16:19], 0
  v_mfma_f32_16x16x32_bf16 v[32:35], v[160:163], v[20:23], v[32:35]
  buffer_load_dwordx4 v[128:131], v4, s[16:19], s36 offen offset:0 nt
  buffer_load_dwordx4 v[132:135], v4, s[16:19], s36 offen offset:2048 nt
  v_mfma_f32_16x16x32_bf16 v[36:39], v[164:167], v[20:23], v[36:39]
  v_mfma_f32_16x16x32_bf16 v[40:43], v[168:171], v[20:23], v[40:43]
  v_mfma_f32_16x16x32_bf16 v[44:47], v[172:175], v[20:23], v[44:47]
  v_mfma_f32_16x16x32_bf16 v[48:51], v[176:179], v[20:23], v[48:51]
  v_mfma_f32_16x16x32_bf16 v[52:55], v[180:183], v[20:23], v[52:55]
  v_mfma_f32_16x16x32_bf16 v[56:59], v[184:187], v[20:23], v[56:59]
  v_mfma_f32_16x16x32_bf16 v[60:63], v[188:191], v[20:23], v[60:63]
  v_max3_f32 v6, v24, v25, v26
  v_max3_f32 v6, v6, v27, v28
  v_max3_f32 v6, v6, v29, v30
  v_max3_f32 v6, v6, v31, v8
  v_mov_b32 v7, v6
  s_nop 1
  v_permlane16_swap_b32 v6, v7
  v_max_f32 v6, v6, v7
  v_mov_b32 v7, v6
  s_nop 1
  v_permlane32_swap_b32 v6, v7
  v_max_f32 v6, v6, v7
  v_cmp_gt_f32 vcc, v6, v8
  v_sub_f32 v7, v8, v6
  buffer_load_dwordx4 v[136:139], v4, s[16:19], s37 offen offset:0 nt
  buffer_load_dwordx4 v[140:143], v4, s[16:19], s37 offen offset:2048 nt
  v_mul_f32 v7, s45, v7
  v_exp_f32 v7, v7
  v_mov_b32 v8, v6
  v_mul_f32 v6, s45, v6
  s_and_b32 s51, vcc_lo, 3
  s_cbranch_scc0 sequential_preLN__gqa_block_cached__glu_gated_bilinear__decode_kernel_norescaleB
  v_mul_f32 v9, v9, v7
  v_readlane_b32 s51, v7, 0
  v_readlane_b32 s52, v7, 1
  s_nop 1
  v_mul_f32 v64, s51, v64
  v_mul_f32 v65, s52, v65
  v_mul_f32 v68, s51, v68
  v_mul_f32 v69, s52, v69
  v_mul_f32 v72, s51, v72
  v_mul_f32 v73, s52, v73
  v_mul_f32 v76, s51, v76
  v_mul_f32 v77, s52, v77
  v_mul_f32 v80, s51, v80
  v_mul_f32 v81, s52, v81
  v_mul_f32 v84, s51, v84
  v_mul_f32 v85, s52, v85
  v_mul_f32 v88, s51, v88
  v_mul_f32 v89, s52, v89
  v_mul_f32 v92, s51, v92
  v_mul_f32 v93, s52, v93
  v_mul_f32 v96, s51, v96
  v_mul_f32 v97, s52, v97
  v_mul_f32 v100, s51, v100
  v_mul_f32 v101, s52, v101
  v_mul_f32 v104, s51, v104
  v_mul_f32 v105, s52, v105
  v_mul_f32 v108, s51, v108
  v_mul_f32 v109, s52, v109
  v_mul_f32 v112, s51, v112
  v_mul_f32 v113, s52, v113
  v_mul_f32 v116, s51, v116
  v_mul_f32 v117, s52, v117
  v_mul_f32 v120, s51, v120
  v_mul_f32 v121, s52, v121
  v_mul_f32 v124, s51, v124
  v_mul_f32 v125, s52, v125
sequential_preLN__gqa_block_cached__glu_gated_bilinear__decode_kernel_norescaleB:
  v_fma_f32 v24, v24, s45, -v6
  buffer_load_dwordx4 v[144:147], v4, s[16:19], s38 offen offset:0 nt
  buffer_load_dwordx4 v[148:151], v4, s[16:19], s38 offen offset:2048 nt
  v_fma_f32 v25, v25, s45, -v6
  v_fma_f32 v26, v26, s45, -v6
  v_fma_f32 v27, v27, s45, -v6
  v_fma_f32 v28, v28, s45, -v6
  v_fma_f32 v29, v29, s45, -v6
  v_fma_f32 v30, v30, s45, -v6
  v_fma_f32 v31, v31, s45, -v6
  v_exp_f32 v24, v24
  v_exp_f32 v25, v25
  v_exp_f32 v26, v26
  v_exp_f32 v27, v27
  v_exp_f32 v28, v28
  v_exp_f32 v29, v29
  v_exp_f32 v30, v30
  v_exp_f32 v31, v31
  v_add_f32 v7, v24, v25
  v_cvt_pk_bf16_f32 v12, v24, v25
  v_add_f32 v9, v9, v7
  v_add_f32 v7, v26, v27
  buffer_load_dwordx4 v[152:155], v4, s[16:19], s39 offen offset:0 nt
  buffer_load_dwordx4 v[156:159], v4, s[16:19], s39 offen offset:2048 nt
  v_cvt_pk_bf16_f32 v13, v26, v27
  v_add_f32 v9, v9, v7
  v_add_f32 v7, v28, v29
  v_cvt_pk_bf16_f32 v14, v28, v29
  v_add_f32 v9, v9, v7
  v_add_f32 v7, v30, v31
  v_cvt_pk_bf16_f32 v15, v30, v31
  v_add_f32 v9, v9, v7
  v_add_f32_dpp v32, v33, v32 row_shl:2 row_mask:0xf bank_mask:0xf
  v_add_f32_dpp v34, v35, v34 row_shl:2 row_mask:0xf bank_mask:0xf
  v_add_f32_dpp v36, v37, v36 row_shl:2 row_mask:0xf bank_mask:0xf
  v_add_f32_dpp v38, v39, v38 row_shl:2 row_mask:0xf bank_mask:0xf
  v_add_f32_dpp v40, v41, v40 row_shl:2 row_mask:0xf bank_mask:0xf
  v_add_f32_dpp v42, v43, v42 row_shl:2 row_mask:0xf bank_mask:0xf
  v_add_f32_dpp v44, v45, v44 row_shl:2 row_mask:0xf bank_mask:0xf
  v_add_f32_dpp v46, v47, v46 row_shl:2 row_mask:0xf bank_mask:0xf
  v_add_f32_dpp v48, v49, v48 row_shl:2 row_mask:0xf bank_mask:0xf
  v_add_f32_dpp v50, v51, v50 row_shl:2 row_mask:0xf bank_mask:0xf
  v_add_f32_dpp v52, v53, v52 row_shl:2 row_mask:0xf bank_mask:0xf
  buffer_load_dwordx4 v[160:163], v4, s[16:19], s36 offen offset:256 nt
  buffer_load_dwordx4 v[164:167], v4, s[16:19], s36 offen offset:2304 nt
  v_add_f32_dpp v54, v55, v54 row_shl:2 row_mask:0xf bank_mask:0xf
  v_add_f32_dpp v56, v57, v56 row_shl:2 row_mask:0xf bank_mask:0xf
  v_add_f32_dpp v58, v59, v58 row_shl:2 row_mask:0xf bank_mask:0xf
  v_add_f32_dpp v60, v61, v60 row_shl:2 row_mask:0xf bank_mask:0xf
  v_add_f32_dpp v62, v63, v62 row_shl:2 row_mask:0xf bank_mask:0xf
  v_add_f32_dpp v24, v34, v32 row_shl:4 row_mask:0xf bank_mask:0xf
  v_add_f32_dpp v25, v38, v36 row_shl:4 row_mask:0xf bank_mask:0xf
  v_add_f32_dpp v26, v42, v40 row_shl:4 row_mask:0xf bank_mask:0xf
  v_add_f32_dpp v27, v46, v44 row_shl:4 row_mask:0xf bank_mask:0xf
  v_add_f32_dpp v28, v50, v48 row_shl:4 row_mask:0xf bank_mask:0xf
  v_add_f32_dpp v29, v54, v52 row_shl:4 row_mask:0xf bank_mask:0xf
  v_add_f32_dpp v30, v58, v56 row_shl:4 row_mask:0xf bank_mask:0xf
  v_add_f32_dpp v31, v62, v60 row_shl:4 row_mask:0xf bank_mask:0xf
  v_cvt_pk_bf16_f32 v7, v24, v25
  v_lshlrev_b32 v24, 16, v7
  v_and_b32 v25, s44, v7
  v_add_f32 v24, s12, v24
  v_add_f32 v25, s12, v25
  v_cvt_pk_bf16_f32 v7, v26, v27
  buffer_load_dwordx4 v[168:171], v4, s[16:19], s37 offen offset:256 nt
  buffer_load_dwordx4 v[172:175], v4, s[16:19], s37 offen offset:2304 nt
  v_lshlrev_b32 v26, 16, v7
  v_and_b32 v27, s44, v7
  v_add_f32 v26, s13, v26
  v_add_f32 v27, s13, v27
  v_cvt_pk_bf16_f32 v7, v28, v29
  v_lshlrev_b32 v28, 16, v7
  v_and_b32 v29, s44, v7
  v_add_f32 v28, s14, v28
  v_add_f32 v29, s14, v29
  v_cvt_pk_bf16_f32 v7, v30, v31
  v_lshlrev_b32 v30, 16, v7
  v_and_b32 v31, s44, v7
  v_add_f32 v30, s15, v30
  v_add_f32 v31, s15, v31
  v_perm_b32 v32, v196, v192, s41
  v_perm_b32 v33, v204, v200, s41
  v_perm_b32 v34, v212, v208, s41
  v_perm_b32 v35, v220, v216, s41
  v_perm_b32 v36, v196, v192, s42
  buffer_load_dwordx4 v[176:179], v4, s[16:19], s38 offen offset:256 nt
  buffer_load_dwordx4 v[180:183], v4, s[16:19], s38 offen offset:2304 nt
  v_perm_b32 v37, v204, v200, s42
  v_perm_b32 v38, v212, v208, s42
  v_perm_b32 v39, v220, v216, s42
  v_mfma_f32_16x16x32_bf16 v[64:67], v[12:15], v[32:35], v[64:67]
  v_perm_b32 v40, v197, v193, s41
  v_perm_b32 v41, v205, v201, s41
  v_perm_b32 v42, v213, v209, s41
  v_perm_b32 v43, v221, v217, s41
  v_mfma_f32_16x16x32_bf16 v[68:71], v[12:15], v[36:39], v[68:71]
  v_perm_b32 v32, v197, v193, s42
  v_perm_b32 v33, v205, v201, s42
  v_perm_b32 v34, v213, v209, s42
  v_perm_b32 v35, v221, v217, s42
  v_mfma_f32_16x16x32_bf16 v[72:75], v[12:15], v[40:43], v[72:75]
  v_perm_b32 v36, v198, v194, s41
  v_perm_b32 v37, v206, v202, s41
  v_perm_b32 v38, v214, v210, s41
  v_perm_b32 v39, v222, v218, s41
  v_mfma_f32_16x16x32_bf16 v[76:79], v[12:15], v[32:35], v[76:79]
  buffer_load_dwordx4 v[184:187], v4, s[16:19], s39 offen offset:256 nt
  buffer_load_dwordx4 v[188:191], v4, s[16:19], s39 offen offset:2304 nt
  v_perm_b32 v40, v198, v194, s42
  v_perm_b32 v41, v206, v202, s42
  v_perm_b32 v42, v214, v210, s42
  v_perm_b32 v43, v222, v218, s42
  v_mfma_f32_16x16x32_bf16 v[80:83], v[12:15], v[36:39], v[80:83]
  v_perm_b32 v32, v199, v195, s41
  v_perm_b32 v33, v207, v203, s41
  v_perm_b32 v34, v215, v211, s41
  v_perm_b32 v35, v223, v219, s41
  v_mfma_f32_16x16x32_bf16 v[84:87], v[12:15], v[40:43], v[84:87]
  v_perm_b32 v36, v199, v195, s42
  v_perm_b32 v37, v207, v203, s42
  v_perm_b32 v38, v215, v211, s42
  v_perm_b32 v39, v223, v219, s42
  v_mfma_f32_16x16x32_bf16 v[88:91], v[12:15], v[32:35], v[88:91]
  s_nop 0
  v_mfma_f32_16x16x32_bf16 v[92:95], v[12:15], v[36:39], v[92:95]
  s_waitcnt vmcnt(16)
  v_perm_b32 v32, v228, v224, s41
  v_perm_b32 v33, v236, v232, s41
  v_perm_b32 v34, v244, v240, s41
  buffer_load_dwordx4 v[192:195], v5, s[20:23], s4 offen offset:0 nt
  buffer_load_dwordx4 v[196:199], v5, s[20:23], s4 offen offset:2048 nt
  v_perm_b32 v35, v252, v248, s41
  v_perm_b32 v36, v228, v224, s42
  v_perm_b32 v37, v236, v232, s42
  v_perm_b32 v38, v244, v240, s42
  v_perm_b32 v39, v252, v248, s42
  v_mfma_f32_16x16x32_bf16 v[96:99], v[12:15], v[32:35], v[96:99]
  v_perm_b32 v40, v229, v225, s41
  v_perm_b32 v41, v237, v233, s41
  v_perm_b32 v42, v245, v241, s41
  v_perm_b32 v43, v253, v249, s41
  v_mfma_f32_16x16x32_bf16 v[100:103], v[12:15], v[36:39], v[100:103]
  v_perm_b32 v32, v229, v225, s42
  v_perm_b32 v33, v237, v233, s42
  v_perm_b32 v34, v245, v241, s42
  v_perm_b32 v35, v253, v249, s42
  v_mfma_f32_16x16x32_bf16 v[104:107], v[12:15], v[40:43], v[104:107]
  v_perm_b32 v36, v230, v226, s41
  v_perm_b32 v37, v238, v234, s41
  v_perm_b32 v38, v246, v242, s41
  buffer_load_dwordx4 v[200:203], v5, s[20:23], s5 offen offset:0 nt
  buffer_load_dwordx4 v[204:207], v5, s[20:23], s5 offen offset:2048 nt
  v_perm_b32 v39, v254, v250, s41
  v_mfma_f32_16x16x32_bf16 v[108:111], v[12:15], v[32:35], v[108:111]
  v_perm_b32 v40, v230, v226, s42
  v_perm_b32 v41, v238, v234, s42
  v_perm_b32 v42, v246, v242, s42
  v_perm_b32 v43, v254, v250, s42
  v_mfma_f32_16x16x32_bf16 v[112:115], v[12:15], v[36:39], v[112:115]
  v_perm_b32 v32, v231, v227, s41
  v_perm_b32 v33, v239, v235, s41
  v_perm_b32 v34, v247, v243, s41
  v_perm_b32 v35, v255, v251, s41
  v_mfma_f32_16x16x32_bf16 v[116:119], v[12:15], v[40:43], v[116:119]
  v_perm_b32 v36, v231, v227, s42
  v_perm_b32 v37, v239, v235, s42
  v_perm_b32 v38, v247, v243, s42
  v_perm_b32 v39, v255, v251, s42
  v_mfma_f32_16x16x32_bf16 v[120:123], v[12:15], v[32:35], v[120:123]
  s_nop 0
  v_mfma_f32_16x16x32_bf16 v[124:127], v[12:15], v[36:39], v[124:127]
  buffer_load_dwordx4 v[208:211], v5, s[20:23], s6 offen offset:0 nt
  buffer_load_dwordx4 v[212:215], v5, s[20:23], s6 offen offset:2048 nt
  buffer_load_dwordx4 v[216:219], v5, s[20:23], s7 offen offset:0 nt
  buffer_load_dwordx4 v[220:223], v5, s[20:23], s7 offen offset:2048 nt
  v_mov_b32 v10, 256
  s_cmp_lt_u32 s99, s86
  s_cselect_b64 exec, 1, 0
  v_mov_b32 v10, 1
  buffer_atomic_add v10, v11, s[32:35], s98 offen sc0 sc1
  s_mov_b64 exec, -1
  buffer_load_dwordx4 v[224:227], v5, s[20:23], s4 offen offset:256 nt
  buffer_load_dwordx4 v[228:231], v5, s[20:23], s4 offen offset:2304 nt
  buffer_load_dwordx4 v[232:235], v5, s[20:23], s5 offen offset:256 nt
  buffer_load_dwordx4 v[236:239], v5, s[20:23], s5 offen offset:2304 nt
  buffer_load_dwordx4 v[240:243], v5, s[20:23], s6 offen offset:256 nt
  buffer_load_dwordx4 v[244:247], v5, s[20:23], s6 offen offset:2304 nt
  buffer_load_dwordx4 v[248:251], v5, s[20:23], s7 offen offset:256 nt
  buffer_load_dwordx4 v[252:255], v5, s[20:23], s7 offen offset:2304 nt
  s_nop 7
  s_branch sequential_preLN__gqa_block_cached__glu_gated_bilinear__decode_kernel_loop
sequential_preLN__gqa_block_cached__glu_gated_bilinear__decode_kernel_loopC:
  s_nop 1
  s_mov_b32 s4, s36
  s_cmp_lt_u32 s36, 0x400000
  s_cselect_b32 s12, 0, 0xff7fffff
  s_mov_b32 s5, s37
  s_cmp_lt_u32 s37, 0x400000
  s_cselect_b32 s13, 0, 0xff7fffff
  s_mov_b32 s6, s38
  s_cmp_lt_u32 s38, 0x400000
  s_cselect_b32 s14, 0, 0xff7fffff
  s_mov_b32 s7, s39
  s_cmp_lt_u32 s39, 0x400000
  s_cselect_b32 s15, 0, 0xff7fffff
  v_mfma_f32_16x16x32_bf16 v[32:35], v[128:131], v[16:19], 0
  v_mfma_f32_16x16x32_bf16 v[36:39], v[132:135], v[16:19], 0
  v_mfma_f32_16x16x32_bf16 v[40:43], v[136:139], v[16:19], 0
  v_mfma_f32_16x16x32_bf16 v[44:47], v[140:143], v[16:19], 0
  v_mfma_f32_16x16x32_bf16 v[48:51], v[144:147], v[16:19], 0
  v_mfma_f32_16x16x32_bf16 v[52:55], v[148:151], v[16:19], 0
  v_mfma_f32_16x16x32_bf16 v[56:59], v[152:155], v[16:19], 0
  v_mfma_f32_16x16x32_bf16 v[60:63], v[156:159], v[16:19], 0
  buffer_load_dwordx4 v[128:131], v5, s[20:23], s4 offen offset:0 nt
  buffer_load_dwordx4 v[132:135], v5, s[20:23], s4 offen offset:2048 nt
  buffer_load_dwordx4 v[136:139], v5, s[20:23], s5 offen offset:0 nt
  buffer_load_dwordx4 v[140:143], v5, s[20:23], s5 offen offset:2048 nt
  buffer_load_dwordx4 v[144:147], v5, s[20:23], s6 offen offset:0 nt
  buffer_load_dwordx4 v[148:151], v5, s[20:23], s6 offen offset:2048 nt
  buffer_load_dwordx4 v[152:155], v5, s[20:23], s7 offen offset:0 nt
  buffer_load_dwordx4 v[156:159], v5, s[20:23], s7 offen offset:2048 nt
  v_mfma_f32_16x16x32_bf16 v[32:35], v[160:163], v[20:23], v[32:35]
  v_mfma_f32_16x16x32_bf16 v[36:39], v[164:167], v[20:23], v[36:39]
  v_mfma_f32_16x16x32_bf16 v[40:43], v[168:171], v[20:23], v[40:43]
  v_mfma_f32_16x16x32_bf16 v[44:47], v[172:175], v[20:23], v[44:47]
  v_mfma_f32_16x16x32_bf16 v[48:51], v[176:179], v[20:23], v[48:51]
  v_mfma_f32_16x16x32_bf16 v[52:55], v[180:183], v[20:23], v[52:55]
  v_mfma_f32_16x16x32_bf16 v[56:59], v[184:187], v[20:23], v[56:59]
  v_mfma_f32_16x16x32_bf16 v[60:63], v[188:191], v[20:23], v[60:63]
  buffer_load_dwordx4 v[160:163], v5, s[20:23], s4 offen offset:256 nt
  buffer_load_dwordx4 v[164:167], v5, s[20:23], s4 offen offset:2304 nt
  buffer_load_dwordx4 v[168:171], v5, s[20:23], s5 offen offset:256 nt
  buffer_load_dwordx4 v[172:175], v5, s[20:23], s5 offen offset:2304 nt
  buffer_load_dwordx4 v[176:179], v5, s[20:23], s6 offen offset:256 nt
  buffer_load_dwordx4 v[180:183], v5, s[20:23], s6 offen offset:2304 nt
  buffer_load_dwordx4 v[184:187], v5, s[20:23], s7 offen offset:256 nt
  buffer_load_dwordx4 v[188:191], v5, s[20:23], s7 offen offset:2304 nt
  v_max3_f32 v6, v24, v25, v26
  v_max3_f32 v6, v6, v27, v28
  v_max3_f32 v6, v6, v29, v30
  v_max3_f32 v6, v6, v31, v8
  v_mov_b32 v7, v6
  s_nop 1
  v_permlane16_swap_b32 v6, v7
  v_max_f32 v6, v6, v7
  v_mov_b32 v7, v6
  s_nop 1
  v_permlane32_swap_b32 v6, v7
  v_max_f32 v6, v6, v7
  v_cmp_gt_f32 vcc, v6, v8
  v_sub_f32 v7, v8, v6
  v_mul_f32 v7, s45, v7
  v_exp_f32 v7, v7
  v_mov_b32 v8, v6
  v_mul_f32 v6, s45, v6
  s_and_b32 s51, vcc_lo, 3
  s_cbranch_scc0 sequential_preLN__gqa_block_cached__glu_gated_bilinear__decode_kernel_norescaleC
  v_mul_f32 v9, v9, v7
  v_readlane_b32 s51, v7, 0
  v_readlane_b32 s52, v7, 1
  s_nop 1
  v_mul_f32 v64, s51, v64
  v_mul_f32 v65, s52, v65
  v_mul_f32 v68, s51, v68
  v_mul_f32 v69, s52, v69
  v_mul_f32 v72, s51, v72
  v_mul_f32 v73, s52, v73
  v_mul_f32 v76, s51, v76
  v_mul_f32 v77, s52, v77
  v_mul_f32 v80, s51, v80
  v_mul_f32 v81, s52, v81
  v_mul_f32 v84, s51, v84
  v_mul_f32 v85, s52, v85
  v_mul_f32 v88, s51, v88
  v_mul_f32 v89, s52, v89
  v_mul_f32 v92, s51, v92
  v_mul_f32 v93, s52, v93
  v_mul_f32 v96, s51, v96
  v_mul_f32 v97, s52, v97
  v_mul_f32 v100, s51, v100
  v_mul_f32 v101, s52, v101
  v_mul_f32 v104, s51, v104
  v_mul_f32 v105, s52, v105
  v_mul_f32 v108, s51, v108
  v_mul_f32 v109, s52, v109
  v_mul_f32 v112, s51, v112
  v_mul_f32 v113, s52, v113
  v_mul_f32 v116, s51, v116
  v_mul_f32 v117, s52, v117
  v_mul_f32 v120, s51, v120
  v_mul_f32 v121, s52, v121
  v_mul_f32 v124, s51, v124
  v_mul_f32 v125, s52, v125
sequential_preLN__gqa_block_cached__glu_gated_bilinear__decode_kernel_norescaleC:
  v_fma_f32 v24, v24, s45, -v6
  v_fma_f32 v25, v25, s45, -v6
  v_fma_f32 v26, v26, s45, -v6
  v_fma_f32 v27, v27, s45, -v6
  v_fma_f32 v28, v28, s45, -v6
  v_fma_f32 v29, v29, s45, -v6
  v_fma_f32 v30, v30, s45, -v6
  v_fma_f32 v31, v31, s45, -v6
  v_exp_f32 v24, v24
  v_exp_f32 v25, v25
  v_exp_f32 v26, v26
  v_exp_f32 v27, v27
  v_exp_f32 v28, v28
  v_exp_f32 v29, v29
  v_exp_f32 v30, v30
  v_exp_f32 v31, v31
  v_add_f32 v7, v24, v25
  v_cvt_pk_bf16_f32 v12, v24, v25
  v_add_f32 v9, v9, v7
  v_add_f32 v7, v26, v27
  v_cvt_pk_bf16_f32 v13, v26, v27
  v_add_f32 v9, v9, v7
  v_add_f32 v7, v28, v29
  v_cvt_pk_bf16_f32 v14, v28, v29
  v_add_f32 v9, v9, v7
  v_add_f32 v7, v30, v31
  v_cvt_pk_bf16_f32 v15, v30, v31
  v_add_f32 v9, v9, v7
  v_add_f32_dpp v32, v33, v32 row_shl:2 row_mask:0xf bank_mask:0xf
  v_add_f32_dpp v34, v35, v34 row_shl:2 row_mask:0xf bank_mask:0xf
  v_add_f32_dpp v36, v37, v36 row_shl:2 row_mask:0xf bank_mask:0xf
  v_add_f32_dpp v38, v39, v38 row_shl:2 row_mask:0xf bank_mask:0xf
  v_add_f32_dpp v40, v41, v40 row_shl:2 row_mask:0xf bank_mask:0xf
  v_add_f32_dpp v42, v43, v42 row_shl:2 row_mask:0xf bank_mask:0xf
  v_add_f32_dpp v44, v45, v44 row_shl:2 row_mask:0xf bank_mask:0xf
  v_add_f32_dpp v46, v47, v46 row_shl:2 row_mask:0xf bank_mask:0xf
  v_add_f32_dpp v48, v49, v48 row_shl:2 row_mask:0xf bank_mask:0xf
  v_add_f32_dpp v50, v51, v50 row_shl:2 row_mask:0xf bank_mask:0xf
  v_add_f32_dpp v52, v53, v52 row_shl:2 row_mask:0xf bank_mask:0xf
  v_add_f32_dpp v54, v55, v54 row_shl:2 row_mask:0xf bank_mask:0xf
  v_add_f32_dpp v56, v57, v56 row_shl:2 row_mask:0xf bank_mask:0xf
  v_add_f32_dpp v58, v59, v58 row_shl:2 row_mask:0xf bank_mask:0xf
  v_add_f32_dpp v60, v61, v60 row_shl:2 row_mask:0xf bank_mask:0xf
  v_add_f32_dpp v62, v63, v62 row_shl:2 row_mask:0xf bank_mask:0xf
  v_add_f32_dpp v24, v34, v32 row_shl:4 row_mask:0xf bank_mask:0xf
  v_add_f32_dpp v25, v38, v36 row_shl:4 row_mask:0xf bank_mask:0xf
  v_add_f32_dpp v26, v42, v40 row_shl:4 row_mask:0xf bank_mask:0xf
  v_add_f32_dpp v27, v46, v44 row_shl:4 row_mask:0xf bank_mask:0xf
  v_add_f32_dpp v28, v50, v48 row_shl:4 row_mask:0xf bank_mask:0xf
  v_add_f32_dpp v29, v54, v52 row_shl:4 row_mask:0xf bank_mask:0xf
  v_add_f32_dpp v30, v58, v56 row_shl:4 row_mask:0xf bank_mask:0xf
  v_add_f32_dpp v31, v62, v60 row_shl:4 row_mask:0xf bank_mask:0xf
  v_cvt_pk_bf16_f32 v7, v24, v25
  v_lshlrev_b32 v24, 16, v7
  v_and_b32 v25, s44, v7
  v_add_f32 v24, s12, v24
  v_add_f32 v25, s12, v25
  v_cvt_pk_bf16_f32 v7, v26, v27
  v_lshlrev_b32 v26, 16, v7
  v_and_b32 v27, s44, v7
  v_add_f32 v26, s13, v26
  v_add_f32 v27, s13, v27
  v_cvt_pk_bf16_f32 v7, v28, v29
  v_lshlrev_b32 v28, 16, v7
  v_and_b32 v29, s44, v7
  v_add_f32 v28, s14, v28
  v_add_f32 v29, s14, v29
  v_cvt_pk_bf16_f32 v7, v30, v31
  v_lshlrev_b32 v30, 16, v7
  v_and_b32 v31, s44, v7
  v_add_f32 v30, s15, v30
  v_add_f32 v31, s15, v31
  v_perm_b32 v32, v196, v192, s41
  v_perm_b32 v33, v204, v200, s41
  v_perm_b32 v34, v212, v208, s41
  v_perm_b32 v35, v220, v216, s41
  v_perm_b32 v36, v196, v192, s42
  v_perm_b32 v37, v204, v200, s42
  v_perm_b32 v38, v212, v208, s42
  v_perm_b32 v39, v220, v216, s42
  v_mfma_f32_16x16x32_bf16 v[64:67], v[12:15], v[32:35], v[64:67]
  v_perm_b32 v40, v197, v193, s41
  v_perm_b32 v41, v205, v201, s41
  v_perm_b32 v42, v213, v209, s41
  v_perm_b32 v43, v221, v217, s41
  v_mfma_f32_16x16x32_bf16 v[68:71], v[12:15], v[36:39], v[68:71]
  v_perm_b32 v32, v197, v193, s42
  v_perm_b32 v33, v205, v201, s42
  v_perm_b32 v34, v213, v209, s42
  v_perm_b32 v35, v221, v217, s42
  v_mfma_f32_16x16x32_bf16 v[72:75], v[12:15], v[40:43], v[72:75]
  v_perm_b32 v36, v198, v194, s41
  v_perm_b32 v37, v206, v202, s41
  v_perm_b32 v38, v214, v210, s41
  v_perm_b32 v39, v222, v218, s41
  v_mfma_f32_16x16x32_bf16 v[76:79], v[12:15], v[32:35], v[76:79]
  v_perm_b32 v40, v198, v194, s42
  v_perm_b32 v41, v206, v202, s42
  v_perm_b32 v42, v214, v210, s42
  v_perm_b32 v43, v222, v218, s42
  v_mfma_f32_16x16x32_bf16 v[80:83], v[12:15], v[36:39], v[80:83]
  v_perm_b32 v32, v199, v195, s41
  v_perm_b32 v33, v207, v203, s41
  v_perm_b32 v34, v215, v211, s41
  v_perm_b32 v35, v223, v219, s41
  v_mfma_f32_16x16x32_bf16 v[84:87], v[12:15], v[40:43], v[84:87]
  v_perm_b32 v36, v199, v195, s42
  v_perm_b32 v37, v207, v203, s42
  v_perm_b32 v38, v215, v211, s42
  v_perm_b32 v39, v223, v219, s42
  v_mfma_f32_16x16x32_bf16 v[88:91], v[12:15], v[32:35], v[88:91]
  s_nop 0
  v_mfma_f32_16x16x32_bf16 v[92:95], v[12:15], v[36:39], v[92:95]
  s_waitcnt vmcnt(16)
  v_perm_b32 v32, v228, v224, s41
  v_perm_b32 v33, v236, v232, s41
  v_perm_b32 v34, v244, v240, s41
  v_perm_b32 v35, v252, v248, s41
  v_perm_b32 v36, v228, v224, s42
  v_perm_b32 v37, v236, v232, s42
  v_perm_b32 v38, v244, v240, s42
  v_perm_b32 v39, v252, v248, s42
  v_mfma_f32_16x16x32_bf16 v[96:99], v[12:15], v[32:35], v[96:99]
  v_perm_b32 v40, v229, v225, s41
  v_perm_b32 v41, v237, v233, s41
  v_perm_b32 v42, v245, v241, s41
  v_perm_b32 v43, v253, v249, s41
  v_mfma_f32_16x16x32_bf16 v[100:103], v[12:15], v[36:39], v[100:103]
  v_perm_b32 v32, v229, v225, s42
  v_perm_b32 v33, v237, v233, s42
  v_perm_b32 v34, v245, v241, s42
  v_perm_b32 v35, v253, v249, s42
  v_mfma_f32_16x16x32_bf16 v[104:107], v[12:15], v[40:43], v[104:107]
  v_perm_b32 v36, v230, v226, s41
  v_perm_b32 v37, v238, v234, s41
  v_perm_b32 v38, v246, v242, s41
  v_perm_b32 v39, v254, v250, s41
  v_mfma_f32_16x16x32_bf16 v[108:111], v[12:15], v[32:35], v[108:111]
  v_perm_b32 v40, v230, v226, s42
  v_perm_b32 v41, v238, v234, s42
  v_perm_b32 v42, v246, v242, s42
  v_perm_b32 v43, v254, v250, s42
  v_mfma_f32_16x16x32_bf16 v[112:115], v[12:15], v[36:39], v[112:115]
  v_perm_b32 v32, v231, v227, s41
  v_perm_b32 v33, v239, v235, s41
  v_perm_b32 v34, v247, v243, s41
  v_perm_b32 v35, v255, v251, s41
  v_mfma_f32_16x16x32_bf16 v[116:119], v[12:15], v[40:43], v[116:119]
  v_perm_b32 v36, v231, v227, s42
  v_perm_b32 v37, v239, v235, s42
  v_perm_b32 v38, v247, v243, s42
  v_perm_b32 v39, v255, v251, s42
  v_mfma_f32_16x16x32_bf16 v[120:123], v[12:15], v[32:35], v[120:123]
  s_nop 0
  v_mfma_f32_16x16x32_bf16 v[124:127], v[12:15], v[36:39], v[124:127]
  s_nop 7
  v_max3_f32 v6, v24, v25, v26
  v_max3_f32 v6, v6, v27, v28
  v_max3_f32 v6, v6, v29, v30
  v_max3_f32 v6, v6, v31, v8
  v_mov_b32 v7, v6
  s_nop 1
  v_permlane16_swap_b32 v6, v7
  v_max_f32 v6, v6, v7
  v_mov_b32 v7, v6
  s_nop 1
  v_permlane32_swap_b32 v6, v7
  v_max_f32 v6, v6, v7
  v_cmp_gt_f32 vcc, v6, v8
  v_sub_f32 v7, v8, v6
  v_mul_f32 v7, s45, v7
  v_exp_f32 v7, v7
  v_mov_b32 v8, v6
  v_mul_f32 v6, s45, v6
  s_and_b32 s51, vcc_lo, 3
  s_cbranch_scc0 sequential_preLN__gqa_block_cached__glu_gated_bilinear__decode_kernel_norescaleD
  v_mul_f32 v9, v9, v7
  v_readlane_b32 s51, v7, 0
  v_readlane_b32 s52, v7, 1
  s_nop 1
  v_mul_f32 v64, s51, v64
  v_mul_f32 v65, s52, v65
  v_mul_f32 v68, s51, v68
  v_mul_f32 v69, s52, v69
  v_mul_f32 v72, s51, v72
  v_mul_f32 v73, s52, v73
  v_mul_f32 v76, s51, v76
  v_mul_f32 v77, s52, v77
  v_mul_f32 v80, s51, v80
  v_mul_f32 v81, s52, v81
  v_mul_f32 v84, s51, v84
  v_mul_f32 v85, s52, v85
  v_mul_f32 v88, s51, v88
  v_mul_f32 v89, s52, v89
  v_mul_f32 v92, s51, v92
  v_mul_f32 v93, s52, v93
  v_mul_f32 v96, s51, v96
  v_mul_f32 v97, s52, v97
  v_mul_f32 v100, s51, v100
  v_mul_f32 v101, s52, v101
  v_mul_f32 v104, s51, v104
  v_mul_f32 v105, s52, v105
  v_mul_f32 v108, s51, v108
  v_mul_f32 v109, s52, v109
  v_mul_f32 v112, s51, v112
  v_mul_f32 v113, s52, v113
  v_mul_f32 v116, s51, v116
  v_mul_f32 v117, s52, v117
  v_mul_f32 v120, s51, v120
  v_mul_f32 v121, s52, v121
  v_mul_f32 v124, s51, v124
  v_mul_f32 v125, s52, v125
sequential_preLN__gqa_block_cached__glu_gated_bilinear__decode_kernel_norescaleD:
  v_fma_f32 v24, v24, s45, -v6
  v_fma_f32 v25, v25, s45, -v6
  v_fma_f32 v26, v26, s45, -v6
  v_fma_f32 v27, v27, s45, -v6
  v_fma_f32 v28, v28, s45, -v6
  v_fma_f32 v29, v29, s45, -v6
  v_fma_f32 v30, v30, s45, -v6
  v_fma_f32 v31, v31, s45, -v6
  v_exp_f32 v24, v24
  v_exp_f32 v25, v25
  v_exp_f32 v26, v26
  v_exp_f32 v27, v27
  v_exp_f32 v28, v28
  v_exp_f32 v29, v29
  v_exp_f32 v30, v30
  v_exp_f32 v31, v31
  v_add_f32 v7, v24, v25
  v_cvt_pk_bf16_f32 v12, v24, v25
  v_add_f32 v9, v9, v7
  v_add_f32 v7, v26, v27
  v_cvt_pk_bf16_f32 v13, v26, v27
  v_add_f32 v9, v9, v7
  v_add_f32 v7, v28, v29
  v_cvt_pk_bf16_f32 v14, v28, v29
  v_add_f32 v9, v9, v7
  v_add_f32 v7, v30, v31
  v_cvt_pk_bf16_f32 v15, v30, v31
  v_add_f32 v9, v9, v7
  s_waitcnt vmcnt(8)
  v_perm_b32 v32, v132, v128, s41
  v_perm_b32 v33, v140, v136, s41
  v_perm_b32 v34, v148, v144, s41
  v_perm_b32 v35, v156, v152, s41
  v_perm_b32 v36, v132, v128, s42
  v_perm_b32 v37, v140, v136, s42
  v_perm_b32 v38, v148, v144, s42
  v_perm_b32 v39, v156, v152, s42
  v_mfma_f32_16x16x32_bf16 v[64:67], v[12:15], v[32:35], v[64:67]
  v_perm_b32 v40, v133, v129, s41
  v_perm_b32 v41, v141, v137, s41
  v_perm_b32 v42, v149, v145, s41
  v_perm_b32 v43, v157, v153, s41
  v_mfma_f32_16x16x32_bf16 v[68:71], v[12:15], v[36:39], v[68:71]
  v_perm_b32 v32, v133, v129, s42
  v_perm_b32 v33, v141, v137, s42
  v_perm_b32 v34, v149, v145, s42
  v_perm_b32 v35, v157, v153, s42
  v_mfma_f32_16x16x32_bf16 v[72:75], v[12:15], v[40:43], v[72:75]
  v_perm_b32 v36, v134, v130, s41
  v_perm_b32 v37, v142, v138, s41
  v_perm_b32 v38, v150, v146, s41
  v_perm_b32 v39, v158, v154, s41
  v_mfma_f32_16x16x32_bf16 v[76:79], v[12:15], v[32:35], v[76:79]
  v_perm_b32 v40, v134, v130, s42
  v_perm_b32 v41, v142, v138, s42
  v_perm_b32 v42, v150, v146, s42
  v_perm_b32 v43, v158, v154, s42
  v_mfma_f32_16x16x32_bf16 v[80:83], v[12:15], v[36:39], v[80:83]
  v_perm_b32 v32, v135, v131, s41
  v_perm_b32 v33, v143, v139, s41
  v_perm_b32 v34, v151, v147, s41
  v_perm_b32 v35, v159, v155, s41
  v_mfma_f32_16x16x32_bf16 v[84:87], v[12:15], v[40:43], v[84:87]
  v_perm_b32 v36, v135, v131, s42
  v_perm_b32 v37, v143, v139, s42
  v_perm_b32 v38, v151, v147, s42
  v_perm_b32 v39, v159, v155, s42
  v_mfma_f32_16x16x32_bf16 v[88:91], v[12:15], v[32:35], v[88:91]
  s_nop 0
  v_mfma_f32_16x16x32_bf16 v[92:95], v[12:15], v[36:39], v[92:95]
  s_waitcnt vmcnt(0)
  v_perm_b32 v32, v164, v160, s41
  v_perm_b32 v33, v172, v168, s41
  v_perm_b32 v34, v180, v176, s41
  v_perm_b32 v35, v188, v184, s41
  v_perm_b32 v36, v164, v160, s42
  v_perm_b32 v37, v172, v168, s42
  v_perm_b32 v38, v180, v176, s42
  v_perm_b32 v39, v188, v184, s42
  v_mfma_f32_16x16x32_bf16 v[96:99], v[12:15], v[32:35], v[96:99]
  v_perm_b32 v40, v165, v161, s41
  v_perm_b32 v41, v173, v169, s41
  v_perm_b32 v42, v181, v177, s41
  v_perm_b32 v43, v189, v185, s41
  v_mfma_f32_16x16x32_bf16 v[100:103], v[12:15], v[36:39], v[100:103]
  v_perm_b32 v32, v165, v161, s42
  v_perm_b32 v33, v173, v169, s42
  v_perm_b32 v34, v181, v177, s42
  v_perm_b32 v35, v189, v185, s42
  v_mfma_f32_16x16x32_bf16 v[104:107], v[12:15], v[40:43], v[104:107]
  v_perm_b32 v36, v166, v162, s41
  v_perm_b32 v37, v174, v170, s41
  v_perm_b32 v38, v182, v178, s41
  v_perm_b32 v39, v190, v186, s41
  v_mfma_f32_16x16x32_bf16 v[108:111], v[12:15], v[32:35], v[108:111]
  v_perm_b32 v40, v166, v162, s42
  v_perm_b32 v41, v174, v170, s42
  v_perm_b32 v42, v182, v178, s42
  v_perm_b32 v43, v190, v186, s42
  v_mfma_f32_16x16x32_bf16 v[112:115], v[12:15], v[36:39], v[112:115]
  v_perm_b32 v32, v167, v163, s41
  v_perm_b32 v33, v175, v171, s41
  v_perm_b32 v34, v183, v179, s41
  v_perm_b32 v35, v191, v187, s41
  v_mfma_f32_16x16x32_bf16 v[116:119], v[12:15], v[40:43], v[116:119]
  v_perm_b32 v36, v167, v163, s42
  v_perm_b32 v37, v175, v171, s42
  v_perm_b32 v38, v183, v179, s42
  v_perm_b32 v39, v191, v187, s42
  v_mfma_f32_16x16x32_bf16 v[120:123], v[12:15], v[32:35], v[120:123]
  s_nop 0
  v_mfma_f32_16x16x32_bf16 v[124:127], v[12:15], v[36:39], v[124:127]
  s_nop 7
sequential_preLN__gqa_block_cached__glu_gated_bilinear__decode_kernel_epi:
  v_mov_b32 v7, v9
  s_nop 1
  v_permlane16_swap_b32 v9, v7
  v_add_f32 v9, v9, v7
  v_mov_b32 v7, v9
  s_nop 1
  v_permlane32_swap_b32 v9, v7
  v_add_f32 v9, v9, v7
  s_waitcnt vmcnt(0)
  v_mov_b32 v12, 0
  s_lshl_b32 s52, s72, 4
  s_add_u32 s52, s52, s3
  s_cmp_eq_u32 s52, 16
  s_cselect_b32 s51, 1089536, s34
  buffer_load_dwordx2 v[20:21], v12, s[32:35], s51 offen sc1
  s_mul_i32 s51, s3, 896
  s_cmp_lg_u32 s72, 3
  s_cselect_b32 s51, 0x10000, s51
  v_lshlrev_b32 v12, 4, v1
  v_min_u32 v12, 880, v12
  buffer_load_dwordx4 v[128:131], v12, s[28:31], s51 offen
  s_lshl_b32 s51, s3, 11
  v_lshl_add_u32 v7, v2, 6, s51
  s_mov_b64 exec, 0xffff
  ds_write_b64 v7, v[64:65] offset:10240
  ds_write_b64 v7, v[68:69] offset:10248
  ds_write_b64 v7, v[72:73] offset:10256
  ds_write_b64 v7, v[76:77] offset:10264
  ds_write_b64 v7, v[80:81] offset:10272
  ds_write_b64 v7, v[84:85] offset:10280
  ds_write_b64 v7, v[88:89] offset:10288
  ds_write_b64 v7, v[92:93] offset:10296
  ds_write_b64 v7, v[96:97] offset:11264
  ds_write_b64 v7, v[100:101] offset:11272
  ds_write_b64 v7, v[104:105] offset:11280
  ds_write_b64 v7, v[108:109] offset:11288
  ds_write_b64 v7, v[112:113] offset:11296
  ds_write_b64 v7, v[116:117] offset:11304
  ds_write_b64 v7, v[120:121] offset:11312
  ds_write_b64 v7, v[124:125] offset:11320
  s_mov_b64 exec, 3
  s_lshl_b32 s51, s3, 4
  v_lshl_add_u32 v7, v2, 3, s51
  ds_write_b64 v7, v[8:9] offset:1024
  s_mov_b64 exec, -1
  s_waitcnt lgkmcnt(0)
  s_cmp_eq_u32 s85, 1
  s_cbranch_scc1 sequential_preLN__gqa_block_cached__glu_gated_bilinear__decode_kernel_nb1
  s_barrier
sequential_preLN__gqa_block_cached__glu_gated_bilinear__decode_kernel_nb1:
  v_lshrrev_b32 v7, 8, v0
  v_lshlrev_b32 v7, 3, v7
  v_lshlrev_b32 v6, 2, v0
  v_and_b32 v11, 255, v0
  v_lshlrev_b32 v11, 3, v11
  v_lshrrev_b32 v12, 1, v7
  v_add_u32 v11, v11, v12
  ds_read_b64 v[32:33], v7 offset:1024
  ds_read_b64 v[34:35], v7 offset:1040
  ds_read_b64 v[36:37], v7 offset:1056
  ds_read_b64 v[38:39], v7 offset:1072
  ds_read_b64 v[40:41], v7 offset:1088
  ds_read_b64 v[42:43], v7 offset:1104
  ds_read_b64 v[44:45], v7 offset:1120
  ds_read_b64 v[46:47], v7 offset:1136
  ds_read_b32 v48, v11 offset:10240
  ds_read_b32 v49, v11 offset:12288
  ds_read_b32 v50, v11 offset:14336
  ds_read_b32 v51, v11 offset:16384
  ds_read_b32 v52, v11 offset:18432
  ds_read_b32 v53, v11 offset:20480
  ds_read_b32 v54, v11 offset:22528
  ds_read_b32 v55, v11 offset:24576
  s_waitcnt lgkmcnt(8)
  v_max3_f32 v8, v32, v34, v36
  v_max3_f32 v8, v8, v38, v40
  v_max3_f32 v8, v8, v42, v44
  v_max_f32 v8, v8, v46
  v_sub_f32 v32, v32, v8
  v_mul_f32 v32, s45, v32
  v_sub_f32 v34, v34, v8
  v_mul_f32 v34, s45, v34
  v_sub_f32 v36, v36, v8
  v_mul_f32 v36, s45, v36
  v_sub_f32 v38, v38, v8
  v_mul_f32 v38, s45, v38
  v_sub_f32 v40, v40, v8
  v_mul_f32 v40, s45, v40
  v_sub_f32 v42, v42, v8
  v_mul_f32 v42, s45, v42
  v_sub_f32 v44, v44, v8
  v_mul_f32 v44, s45, v44
  v_sub_f32 v46, v46, v8
  v_mul_f32 v46, s45, v46
  v_exp_f32 v32, v32
  v_exp_f32 v34, v34
  v_exp_f32 v36, v36
  v_exp_f32 v38, v38
  v_exp_f32 v40, v40
  v_exp_f32 v42, v42
  v_exp_f32 v44, v44
  v_exp_f32 v46, v46
  v_mul_f32 v9, v32, v33
  v_fmac_f32 v9, v34, v35
  v_fmac_f32 v9, v36, v37
  v_fmac_f32 v9, v38, v39
  v_fmac_f32 v9, v40, v41
  v_fmac_f32 v9, v42, v43
  v_fmac_f32 v9, v44, v45
  v_fmac_f32 v9, v46, v47
  s_waitcnt lgkmcnt(0)
  v_mul_f32 v10, v32, v48
  v_fmac_f32 v10, v34, v49
  v_fmac_f32 v10, v36, v50
  v_fmac_f32 v10, v38, v51
  v_fmac_f32 v10, v40, v52
  v_fmac_f32 v10, v42, v53
  v_fmac_f32 v10, v44, v54
  v_fmac_f32 v10, v46, v55
  s_lshl_b32 s51, s96, 12
  buffer_store_dword v10, v6, s[24:27], s51 offen sc1
  s_and_b32 s52, s3, 3
  s_cmp_lg_u32 s52, 0
  s_cselect_b32 s51, 1867776, s51
  s_mov_b64 exec, 1
  buffer_store_dwordx2 v[8:9], v7, s[24:27], s51 offen offset:2048 sc1
  s_mov_b64 exec, -1
  s_waitcnt vmcnt(0)
  s_barrier
  s_cmp_lg_u32 s3, 0
  s_cbranch_scc1 sequential_preLN__gqa_block_cached__glu_gated_bilinear__decode_kernel_f1done
  v_mov_b32 v12, s62
  v_mov_b32 v13, s63
  v_mov_b32 v14, 0
  s_lshl_b32 s51, s43, 5
  s_lshl_b32 s52, s47, 3
  s_add_u32 s51, s51, s52
  s_add_u32 s51, s51, s46
  s_lshl_b32 s51, s51, 7
  s_add_u32 s51, s51, 1048576
  s_mov_b64 exec, 1
  buffer_store_dwordx2 v[12:13], v14, s[24:27], s51 offen sc1
  s_mov_b64 exec, -1
sequential_preLN__gqa_block_cached__glu_gated_bilinear__decode_kernel_f1done:
  s_cmp_eq_u32 s72, 0
  s_cbranch_scc1 sequential_preLN__gqa_block_cached__glu_gated_bilinear__decode_kernel_done
  s_cmp_eq_u32 s72, 2
  s_cbranch_scc1 sequential_preLN__gqa_block_cached__glu_gated_bilinear__decode_kernel_done
  s_cmp_eq_u32 s72, 3
  s_cbranch_scc1 sequential_preLN__gqa_block_cached__glu_gated_bilinear__decode_kernel_stageB
  s_cmp_eq_u32 s72, 4
  s_cbranch_scc1 sequential_preLN__gqa_block_cached__glu_gated_bilinear__decode_kernel_stageC
  s_cmp_lg_u32 s3, 0
  s_cbranch_scc1 sequential_preLN__gqa_block_cached__glu_gated_bilinear__decode_kernel_stok
  v_mov_b32 v12, 0
  s_mov_b32 s52, 1089536
  s_waitcnt vmcnt(0)
sequential_preLN__gqa_block_cached__glu_gated_bilinear__decode_kernel_stchk:
  v_readfirstlane_b32 s50, v20
  v_readfirstlane_b32 s51, v21
  s_nop 0
  s_cmp_eq_u64 s[50:51], s[62:63]
  s_cbranch_scc1 sequential_preLN__gqa_block_cached__glu_gated_bilinear__decode_kernel_stok
  s_cmp_eq_u32 s80, 0
  s_cbranch_scc1 sequential_preLN__gqa_block_cached__glu_gated_bilinear__decode_kernel_stok
  s_sub_u32 s80, s80, 1
  s_sleep 16
  buffer_load_dwordx2 v[20:21], v12, s[32:35], s52 offen sc1
  s_waitcnt vmcnt(0)
  s_branch sequential_preLN__gqa_block_cached__glu_gated_bilinear__decode_kernel_stchk
sequential_preLN__gqa_block_cached__glu_gated_bilinear__decode_kernel_stok:
  s_nop 1
  v_lshlrev_b32 v6, 4, v1
  v_mov_b32 v7, 0
  s_and_b32 s50, s73, 15
  s_lshr_b32 s51, s50, 1
  s_lshl_b32 s52, s3, 3
  s_add_u32 s51, s51, s52
  s_lshl_b32 s51, s51, 12
  s_and_b32 s50, s50, 1
  s_lshl_b32 s52, s50, 3
  s_add_u32 s74, s51, s52
  s_lshl_b32 s50, s50, 10
  s_add_u32 s50, s50, s51
  s_add_u32 s81, s50, 0x40000
  s_add_u32 s82, s50, 0x80000
  s_add_u32 s83, s50, 0xC0000
  s_add_u32 s75, s74, 0x40000
  s_add_u32 s86, s74, 0x80000
  s_add_u32 s87, s74, 0xC0000
  s_lshl_b32 s51, s3, 10
  v_lshl_add_u32 v12, v1, 4, s51
  s_cmp_ge_u32 s3, 4
  s_cbranch_scc1 sequential_preLN__gqa_block_cached__glu_gated_bilinear__decode_kernel_A_poll
  ds_read_b128 v[136:139], v12 offset:29696
  ds_read_b128 v[140:143], v12 offset:33792
  ds_read_b128 v[144:147], v12 offset:37888
  ds_read_b128 v[148:151], v12 offset:41984
  ds_read_b128 v[152:155], v12 offset:46080
  ds_read_b128 v[156:159], v12 offset:50176
  ds_read_b128 v[160:163], v12 offset:54272
  ds_read_b128 v[164:167], v12 offset:58368
sequential_preLN__gqa_block_cached__glu_gated_bilinear__decode_kernel_A_poll:
  s_nop 1
  s_cmp_lg_u32 s3, 0
  s_cbranch_scc1 sequential_preLN__gqa_block_cached__glu_gated_bilinear__decode_kernel_A1_go
  s_and_b32 s51, s73, 15
  s_lshr_b32 s51, s51, 1
  s_lshl_b32 s51, s51, 12
  s_add_u32 s51, s51, 1048576
  v_lshlrev_b32 v22, 7, v1
  v_min_u32 v22, 3968, v22
sequential_preLN__gqa_block_cached__glu_gated_bilinear__decode_kernel_A1_poll:
  buffer_load_dwordx2 v[32:33], v22, s[32:35], s51 offen sc1
  s_waitcnt vmcnt(0)
  v_xor_b32 v32, s62, v32
  v_xor_b32 v33, s63, v33
  v_or_b32 v8, v32, v33
  v_cmp_ne_u32 vcc, 0, v8
  s_nop 1
  s_cbranch_vccz sequential_preLN__gqa_block_cached__glu_gated_bilinear__decode_kernel_A1_go
  s_cmp_eq_u32 s80, 0
  s_cbranch_scc1 sequential_preLN__gqa_block_cached__glu_gated_bilinear__decode_kernel_A1_go
  s_sub_u32 s80, s80, 1
  s_sleep 1
  s_branch sequential_preLN__gqa_block_cached__glu_gated_bilinear__decode_kernel_A1_poll
sequential_preLN__gqa_block_cached__glu_gated_bilinear__decode_kernel_A1_go:
  s_nop 1
  s_barrier
sequential_preLN__gqa_block_cached__glu_gated_bilinear__decode_kernel_A_ld:
  buffer_load_dwordx2 v[32:33], v7, s[32:35], s74 offen offset:2048 sc1
  buffer_load_dwordx2 v[34:35], v7, s[32:35], s75 offen offset:2048 sc1
  buffer_load_dwordx2 v[36:37], v7, s[32:35], s86 offen offset:2048 sc1
  buffer_load_dwordx2 v[38:39], v7, s[32:35], s87 offen offset:2048 sc1
  buffer_load_dwordx4 v[40:43], v6, s[32:35], s50 offen sc1
  buffer_load_dwordx4 v[44:47], v6, s[32:35], s81 offen sc1
  buffer_load_dwordx4 v[48:51], v6, s[32:35], s82 offen sc1
  buffer_load_dwordx4 v[52:55], v6, s[32:35], s83 offen sc1
  s_mul_i32 s51, s3, 544
  v_lshl_add_u32 v12, v1, 3, s51
  v_and_b32 v5, 7, v2
  v_mul_u32_u24 v5, 544, v5
  v_lshl_add_u32 v5, v3, 4, v5
  s_waitcnt vmcnt(4)
  v_max3_f32 v8, v32, v34, v36
  v_max_f32 v8, v8, v38
  v_sub_f32 v32, v32, v8
  v_mul_f32 v32, s45, v32
  v_sub_f32 v34, v34, v8
  v_mul_f32 v34, s45, v34
  v_sub_f32 v36, v36, v8
  v_mul_f32 v36, s45, v36
  v_sub_f32 v38, v38, v8
  v_mul_f32 v38, s45, v38
  v_exp_f32 v32, v32
  v_exp_f32 v34, v34
  v_exp_f32 v36, v36
  v_exp_f32 v38, v38
  v_mul_f32 v9, v32, v33
  v_fmac_f32 v9, v34, v35
  v_fmac_f32 v9, v36, v37
  v_fmac_f32 v9, v38, v39
  v_rcp_f32 v9, v9
  s_nop 0
  v_mul_f32 v32, v32, v9
  v_mul_f32 v34, v34, v9
  v_mul_f32 v36, v36, v9
  v_mul_f32 v38, v38, v9
  s_waitcnt vmcnt(0)
  v_mul_f32 v40, v32, v40
  v_fmac_f32 v40, v34, v44
  v_fmac_f32 v40, v36, v48
  v_fmac_f32 v40, v38, v52
  v_mul_f32 v41, v32, v41
  v_fmac_f32 v41, v34, v45
  v_fmac_f32 v41, v36, v49
  v_fmac_f32 v41, v38, v53
  v_mul_f32 v42, v32, v42
  v_fmac_f32 v42, v34, v46
  v_fmac_f32 v42, v36, v50
  v_fmac_f32 v42, v38, v54
  v_mul_f32 v43, v32, v43
  v_fmac_f32 v43, v34, v47
  v_fmac_f32 v43, v36, v51
  v_fmac_f32 v43, v38, v55
  v_cvt_pk_bf16_f32 v16, v40, v41
  v_cvt_pk_bf16_f32 v17, v42, v43
  ds_write_b64 v12, v[16:17] offset:1280
  s_waitcnt lgkmcnt(0)
  s_barrier
  s_cmp_ge_u32 s3, 4
  s_cbranch_scc1 sequential_preLN__gqa_block_cached__glu_gated_bilinear__decode_kernel_A_bar2
  ds_read_b128 v[40:43], v5 offset:1280
  ds_read_b128 v[44:47], v5 offset:1344
  ds_read_b128 v[48:51], v5 offset:1408
  ds_read_b128 v[52:55], v5 offset:1472
  ds_read_b128 v[56:59], v5 offset:1536
  ds_read_b128 v[60:63], v5 offset:1600
  ds_read_b128 v[64:67], v5 offset:1664
  ds_read_b128 v[68:71], v5 offset:1728
  v_mul_u32_u24 v6, 7168, v3
  v_lshl_add_u32 v6, v2, 2, v6
  s_lshr_b32 s51, s73, 4
  s_lshl_b32 s51, s51, 8
  s_lshl_b32 s52, s3, 6
  s_add_u32 s51, s51, s52
  s_add_u32 s51, s51, 1114112
  s_add_u32 s52, s51, 3584
  s_waitcnt lgkmcnt(7)
  v_mfma_f32_16x16x32_bf16 v[24:27], v[40:43], v[136:139], 0
  s_waitcnt lgkmcnt(6)
  v_mfma_f32_16x16x32_bf16 v[24:27], v[44:47], v[140:143], v[24:27]
  s_waitcnt lgkmcnt(5)
  v_mfma_f32_16x16x32_bf16 v[24:27], v[48:51], v[144:147], v[24:27]
  s_waitcnt lgkmcnt(4)
  v_mfma_f32_16x16x32_bf16 v[24:27], v[52:55], v[148:151], v[24:27]
  s_waitcnt lgkmcnt(3)
  v_mfma_f32_16x16x32_bf16 v[24:27], v[56:59], v[152:155], v[24:27]
  s_waitcnt lgkmcnt(2)
  v_mfma_f32_16x16x32_bf16 v[24:27], v[60:63], v[156:159], v[24:27]
  s_waitcnt lgkmcnt(1)
  v_mfma_f32_16x16x32_bf16 v[24:27], v[64:67], v[160:163], v[24:27]
  s_waitcnt lgkmcnt(0)
  v_mfma_f32_16x16x32_bf16 v[24:27], v[68:71], v[164:167], v[24:27]
  s_mov_b32 exec_lo, -1
  s_mov_b32 exec_hi, 0
  s_nop 5
  buffer_atomic_add_f32 v24, v6, s[24:27], s51 offen
  buffer_atomic_add_f32 v25, v6, s[24:27], s51 offen offset:1792
  buffer_atomic_add_f32 v26, v6, s[24:27], s52 offen
  buffer_atomic_add_f32 v27, v6, s[24:27], s52 offen offset:1792
  s_mov_b64 exec, -1
  s_waitcnt vmcnt(0)
sequential_preLN__gqa_block_cached__glu_gated_bilinear__decode_kernel_A_bar2:
  s_nop 1
  s_cmp_eq_u32 s85, 1
  s_cbranch_scc1 sequential_preLN__gqa_block_cached__glu_gated_bilinear__decode_kernel_nb4
  s_barrier
sequential_preLN__gqa_block_cached__glu_gated_bilinear__decode_kernel_nb4:
  s_cmp_lg_u32 s3, 0
  s_cbranch_scc1 sequential_preLN__gqa_block_cached__glu_gated_bilinear__decode_kernel_done
  v_mov_b32 v8, s62
  v_mov_b32 v9, s63
  v_lshlrev_b32 v10, 11, v1
  s_lshl_b32 s51, s73, 3
  s_add_u32 s51, s51, 1179648
  s_mov_b64 exec, 255
  buffer_store_dwordx2 v[8:9], v10, s[24:27], s51 offen sc1
  s_mov_b64 exec, -1
  s_branch sequential_preLN__gqa_block_cached__glu_gated_bilinear__decode_kernel_done
sequential_preLN__gqa_block_cached__glu_gated_bilinear__decode_kernel_stageB:
  s_nop 1
  s_mul_i32 s51, s3, 14336
  s_add_u32 s51, s51, 29696
  v_lshl_add_u32 v6, v1, 4, s51
  ds_read_b128 v[132:135], v6 offset:0
  ds_read_b128 v[136:139], v6 offset:1024
  ds_read_b128 v[140:143], v6 offset:2048
  ds_read_b128 v[144:147], v6 offset:3072
  ds_read_b128 v[148:151], v6 offset:4096
  ds_read_b128 v[152:155], v6 offset:5120
  ds_read_b128 v[156:159], v6 offset:6144
  ds_read_b128 v[160:163], v6 offset:7168
  ds_read_b128 v[164:167], v6 offset:8192
  ds_read_b128 v[168:171], v6 offset:9216
  ds_read_b128 v[172:175], v6 offset:10240
  ds_read_b128 v[176:179], v6 offset:11264
  ds_read_b128 v[180:183], v6 offset:12288
  ds_read_b128 v[184:187], v6 offset:13312
  v_lshlrev_b32 v6, 5, v1
  v_min_u32 v6, 1760, v6
  s_cmp_lg_u32 s3, 0
  s_cbranch_scc1 sequential_preLN__gqa_block_cached__glu_gated_bilinear__decode_kernel_B_go
  s_and_b32 s51, s2, 7
  s_lshl_b32 s51, s51, 11
  s_add_u32 s51, s51, 1179648
  v_lshlrev_b32 v22, 7, v1
  v_min_u32 v22, 8064, v22
  v_lshlrev_b32 v22, 4, v1
  v_min_u32 v22, 880, v22
sequential_preLN__gqa_block_cached__glu_gated_bilinear__decode_kernel_B_poll:
  buffer_load_dwordx4 v[32:35], v22, s[32:35], s51 offen sc1
  s_waitcnt vmcnt(0)
  v_xor_b32 v32, s62, v32
  v_xor_b32 v33, s63, v33
  v_xor_b32 v34, s62, v34
  v_xor_b32 v35, s63, v35
  v_or3_b32 v8, v32, v33, v34
  v_or_b32 v8, v8, v35
  v_cmp_ne_u32 vcc, 0, v8
  s_nop 1
  s_cbranch_vccz sequential_preLN__gqa_block_cached__glu_gated_bilinear__decode_kernel_B_go
  s_cmp_eq_u32 s80, 0
  s_cbranch_scc1 sequential_preLN__gqa_block_cached__glu_gated_bilinear__decode_kernel_B_go
  s_sub_u32 s80, s80, 1
  s_sleep 1
  s_branch sequential_preLN__gqa_block_cached__glu_gated_bilinear__decode_kernel_B_poll
sequential_preLN__gqa_block_cached__glu_gated_bilinear__decode_kernel_B_go:
  s_nop 1
  s_barrier
  s_mul_i32 s52, s3, 1792
  s_add_u32 s52, s52, 1114112
  buffer_load_dwordx4 v[32:35], v6, s[32:35], s52 offen sc1
  buffer_load_dwordx4 v[36:39], v6, s[32:35], s52 offen offset:16 sc1
  v_and_b32 v5, 7, v2
  v_mul_u32_u24 v18, 3584, v5
  v_lshl_add_u32 v18, v3, 3, v18
  v_mul_u32_u24 v5, 1056, v5
  v_lshl_add_u32 v5, v3, 4, v5
  s_lshl_b32 s53, s73, 7
  s_lshl_b32 s52, s3, 4
  s_add_u32 s53, s53, s52
  s_add_u32 s53, s53, 1146880
  s_waitcnt vmcnt(0)
  v_cvt_pk_bf16_f32 v11, v32, v33
  v_lshlrev_b32 v32, 16, v11
  v_and_b32 v33, s44, v11
  v_lshlrev_b32 v11, 16, v128
  v_add_f32 v32, v32, v11
  v_and_b32 v11, s44, v128
  v_add_f32 v33, v33, v11
  v_cvt_pk_bf16_f32 v11, v32, v33
  v_lshlrev_b32 v32, 16, v11
  v_and_b32 v33, s44, v11
  v_cvt_pk_bf16_f32 v11, v34, v35
  v_lshlrev_b32 v34, 16, v11
  v_and_b32 v35, s44, v11
  v_lshlrev_b32 v11, 16, v129
  v_add_f32 v34, v34, v11
  v_and_b32 v11, s44, v129
  v_add_f32 v35, v35, v11
  v_cvt_pk_bf16_f32 v11, v34, v35
  v_lshlrev_b32 v34, 16, v11
  v_and_b32 v35, s44, v11
  v_cvt_pk_bf16_f32 v11, v36, v37
  v_lshlrev_b32 v36, 16, v11
  v_and_b32 v37, s44, v11
  v_lshlrev_b32 v11, 16, v130
  v_add_f32 v36, v36, v11
  v_and_b32 v11, s44, v130
  v_add_f32 v37, v37, v11
  v_cvt_pk_bf16_f32 v11, v36, v37
  v_lshlrev_b32 v36, 16, v11
  v_and_b32 v37, s44, v11
  v_cvt_pk_bf16_f32 v11, v38, v39
  v_lshlrev_b32 v38, 16, v11
  v_and_b32 v39, s44, v11
  v_lshlrev_b32 v11, 16, v131
  v_add_f32 v38, v38, v11
  v_and_b32 v11, s44, v131
  v_add_f32 v39, v39, v11
  v_cvt_pk_bf16_f32 v11, v38, v39
  v_lshlrev_b32 v38, 16, v11
  v_and_b32 v39, s44, v11
  v_readfirstlane_b32 s51, v32
  v_cmp_gt_u32 vcc, 56, v1
  s_nop 0
  v_subrev_f32 v40, s51, v32
  v_subrev_f32 v42, s51, v33
  v_mul_f32 v41, v40, v40
  v_add_f32 v40, v40, v42
  v_fmac_f32 v41, v42, v42
  v_subrev_f32 v42, s51, v34
  v_add_f32 v40, v40, v42
  v_fmac_f32 v41, v42, v42
  v_subrev_f32 v43, s51, v35
  v_add_f32 v40, v40, v43
  v_fmac_f32 v41, v43, v43
  v_subrev_f32 v42, s51, v36
  v_add_f32 v40, v40, v42
  v_fmac_f32 v41, v42, v42
  v_subrev_f32 v43, s51, v37
  v_add_f32 v40, v40, v43
  v_fmac_f32 v41, v43, v43
  v_subrev_f32 v42, s51, v38
  v_add_f32 v40, v40, v42
  v_fmac_f32 v41, v42, v42
  v_subrev_f32 v43, s51, v39
  v_add_f32 v40, v40, v43
  v_fmac_f32 v41, v43, v43
  v_cndmask_b32 v40, 0, v40, vcc
  v_cndmask_b32 v41, 0, v41, vcc
  s_nop 0
  v_add_f32_dpp v40, v40, v40 quad_perm:[1,0,3,2] row_mask:0xf bank_mask:0xf
  v_add_f32_dpp v41, v41, v41 quad_perm:[1,0,3,2] row_mask:0xf bank_mask:0xf
  s_nop 0
  v_add_f32_dpp v40, v40, v40 quad_perm:[2,3,0,1] row_mask:0xf bank_mask:0xf
  v_add_f32_dpp v41, v41, v41 quad_perm:[2,3,0,1] row_mask:0xf bank_mask:0xf
  s_nop 0
  v_add_f32_dpp v40, v40, v40 row_half_mirror row_mask:0xf bank_mask:0xf
  v_add_f32_dpp v41, v41, v41 row_half_mirror row_mask:0xf bank_mask:0xf
  s_nop 0
  v_add_f32_dpp v40, v40, v40 row_mirror row_mask:0xf bank_mask:0xf
  v_add_f32_dpp v41, v41, v41 row_mirror row_mask:0xf bank_mask:0xf
  v_mov_b32 v42, v40
  v_mov_b32 v43, v41
  s_nop 0
  v_permlane16_swap_b32 v40, v42
  v_permlane16_swap_b32 v41, v43
  v_add_f32 v40, v40, v42
  v_add_f32 v41, v41, v43
  v_mov_b32 v42, v40
  v_mov_b32 v43, v41
  s_nop 0
  v_permlane32_swap_b32 v40, v42
  v_permlane32_swap_b32 v41, v43
  v_add_f32 v40, v40, v42
  v_add_f32 v41, v41, v43
  v_mul_f32 v40, 0x3b124925, v40
  v_mul_f32 v41, 0x3b124925, v41
  v_fma_f32 v41, -v40, v40, v41
  v_max_f32 v41, 0, v41
  v_add_f32 v40, s51, v40
  v_cvt_pk_bf16_f32 v42, v40, v41
  v_lshlrev_b32 v40, 16, v42
  v_and_b32 v41, s44, v42
  v_add_f32 v41, 0x3727c5ac, v41
  v_cvt_pk_bf16_f32 v41, v41, v41
  v_lshlrev_b32 v41, 16, v41
  v_sqrt_f32 v41, v41
  v_sub_f32 v32, v32, v40
  v_sub_f32 v33, v33, v40
  v_sub_f32 v34, v34, v40
  v_sub_f32 v35, v35, v40
  v_sub_f32 v36, v36, v40
  v_sub_f32 v37, v37, v40
  v_sub_f32 v38, v38, v40
  v_sub_f32 v39, v39, v40
  v_cvt_pk_bf16_f32 v41, v41, v41
  v_lshlrev_b32 v41, 16, v41
  v_rcp_f32 v41, v41
  v_cvt_pk_bf16_f32 v42, v32, v33
  v_lshlrev_b32 v32, 16, v42
  v_and_b32 v33, s44, v42
  v_mul_f32 v32, v32, v41
  v_mul_f32 v33, v33, v41
  v_cvt_pk_bf16_f32 v12, v32, v33
  v_cvt_pk_bf16_f32 v42, v34, v35
  v_lshlrev_b32 v34, 16, v42
  v_and_b32 v35, s44, v42
  v_mul_f32 v34, v34, v41
  v_mul_f32 v35, v35, v41
  v_cvt_pk_bf16_f32 v13, v34, v35
  v_cvt_pk_bf16_f32 v42, v36, v37
  v_lshlrev_b32 v36, 16, v42
  v_and_b32 v37, s44, v42
  v_mul_f32 v36, v36, v41
  v_mul_f32 v37, v37, v41
  v_cvt_pk_bf16_f32 v14, v36, v37
  v_cvt_pk_bf16_f32 v42, v38, v39
  v_lshlrev_b32 v38, 16, v42
  v_and_b32 v39, s44, v42
  v_mul_f32 v38, v38, v41
  v_mul_f32 v39, v39, v41
  v_cvt_pk_bf16_f32 v15, v38, v39
  s_mul_i32 s51, s3, 1056
  v_lshl_add_u32 v6, v1, 4, s51
  ds_write_b128 v6, v[12:15] offset:1280
  s_waitcnt lgkmcnt(0)
  s_cmp_eq_u32 s85, 1
  s_cbranch_scc1 sequential_preLN__gqa_block_cached__glu_gated_bilinear__decode_kernel_nb5
  s_barrier
sequential_preLN__gqa_block_cached__glu_gated_bilinear__decode_kernel_nb5:
  ds_read_b128 v[32:35], v5 offset:1280
  ds_read_b128 v[36:39], v5 offset:1344
  ds_read_b128 v[40:43], v5 offset:1408
  ds_read_b128 v[44:47], v5 offset:1472
  ds_read_b128 v[48:51], v5 offset:1536
  ds_read_b128 v[52:55], v5 offset:1600
  ds_read_b128 v[56:59], v5 offset:1664
  ds_read_b128 v[60:63], v5 offset:1728
  ds_read_b128 v[64:67], v5 offset:1792
  ds_read_b128 v[68:71], v5 offset:1856
  ds_read_b128 v[72:75], v5 offset:1920
  ds_read_b128 v[76:79], v5 offset:1984
  ds_read_b128 v[80:83], v5 offset:2048
  ds_read_b128 v[84:87], v5 offset:2112
  s_waitcnt lgkmcnt(13)
  v_mfma_f32_16x16x32_bf16 v[24:27], v[132:135], v[32:35], 0
  s_waitcnt lgkmcnt(12)
  v_mfma_f32_16x16x32_bf16 v[24:27], v[136:139], v[36:39], v[24:27]
  s_waitcnt lgkmcnt(11)
  v_mfma_f32_16x16x32_bf16 v[24:27], v[140:143], v[40:43], v[24:27]
  s_waitcnt lgkmcnt(10)
  v_mfma_f32_16x16x32_bf16 v[24:27], v[144:147], v[44:47], v[24:27]
  s_waitcnt lgkmcnt(9)
  v_mfma_f32_16x16x32_bf16 v[24:27], v[148:151], v[48:51], v[24:27]
  s_waitcnt lgkmcnt(8)
  v_mfma_f32_16x16x32_bf16 v[24:27], v[152:155], v[52:55], v[24:27]
  s_waitcnt lgkmcnt(7)
  v_mfma_f32_16x16x32_bf16 v[24:27], v[156:159], v[56:59], v[24:27]
  s_waitcnt lgkmcnt(6)
  v_mfma_f32_16x16x32_bf16 v[24:27], v[160:163], v[60:63], v[24:27]
  s_waitcnt lgkmcnt(5)
  v_mfma_f32_16x16x32_bf16 v[24:27], v[164:167], v[64:67], v[24:27]
  s_waitcnt lgkmcnt(4)
  v_mfma_f32_16x16x32_bf16 v[24:27], v[168:171], v[68:71], v[24:27]
  s_waitcnt lgkmcnt(3)
  v_mfma_f32_16x16x32_bf16 v[24:27], v[172:175], v[72:75], v[24:27]
  s_waitcnt lgkmcnt(2)
  v_mfma_f32_16x16x32_bf16 v[24:27], v[176:179], v[76:79], v[24:27]
  s_waitcnt lgkmcnt(1)
  v_mfma_f32_16x16x32_bf16 v[24:27], v[180:183], v[80:83], v[24:27]
  s_waitcnt lgkmcnt(0)
  v_mfma_f32_16x16x32_bf16 v[24:27], v[184:187], v[84:87], v[24:27]
  s_nop 7
  v_cvt_pk_bf16_f32 v24, v24, v24
  v_lshlrev_b32 v24, 16, v24
  v_cvt_pk_bf16_f32 v25, v25, v25
  v_lshlrev_b32 v25, 16, v25
  v_cvt_pk_bf16_f32 v26, v26, v26
  v_lshlrev_b32 v26, 16, v26
  v_cvt_pk_bf16_f32 v27, v27, v27
  v_lshlrev_b32 v27, 16, v27
  v_mov_b32 v28, v24
  v_mov_b32 v29, v25
  v_mov_b32 v30, v26
  v_mov_b32 v31, v27
  v_permlane32_swap_b32 v24, v28
  v_permlane32_swap_b32 v25, v29
  v_permlane32_swap_b32 v26, v30
  v_permlane32_swap_b32 v27, v31
  v_mul_f32 v28, v24, v28
  v_mul_f32 v29, v25, v29
  v_mul_f32 v30, v26, v30
  v_mul_f32 v31, v27, v31
  v_cvt_pk_bf16_f32 v28, v28, v29
  v_cvt_pk_bf16_f32 v29, v30, v31
  s_mov_b32 exec_lo, 0x00ff00ff
  s_mov_b32 exec_hi, 0
  buffer_store_dwordx2 v[28:29], v18, s[24:27], s53 offen sc1
  v_mov_b32 v8, s62
  v_mov_b32 v9, s63
  v_mov_b32 v10, 0
  s_lshl_b32 s51, s73, 7
  s_add_u32 s51, s51, 1081344
  s_cmp_lg_u32 s3, 7
  s_cselect_b32 s51, s34, s51
  s_mov_b64 exec, 1
  buffer_store_dwordx2 v[8:9], v10, s[24:27], s51 offen sc1
  s_mov_b64 exec, -1
  s_branch sequential_preLN__gqa_block_cached__glu_gated_bilinear__decode_kernel_done
sequential_preLN__gqa_block_cached__glu_gated_bilinear__decode_kernel_stageC:
  s_cmp_eq_u32 s3, 0
  s_cbranch_scc1 sequential_preLN__gqa_block_cached__glu_gated_bilinear__decode_kernel_C_pre
  s_sub_u32 s53, s3, 1
  s_mov_b32 s56, s68
  s_mov_b32 s57, s69
  s_mov_b32 s58, 1605632
  s_mov_b32 s59, 0x00020000
  v_lshrrev_b32 v12, 2, v1
  v_mul_u32_u24 v6, 7168, v12
  v_and_b32 v13, 3, v1
  v_lshl_add_u32 v6, v13, 4, v6
  s_mul_i32 s51, s53, 229376
  s_lshl_b32 s54, s73, 6
  s_add_u32 s51, s51, s54
  s_add_u32 s40, s51, 114688
  s_mov_b32 s52, 896
  v_lshlrev_b32 v24, 11, v3
  v_lshrrev_b32 v14, 1, v13
  v_lshl_add_u32 v24, v14, 10, v24
  v_and_b32 v14, 3, v12
  v_lshl_add_u32 v24, v14, 8, v24
  v_and_b32 v14, 1, v1
  v_lshl_add_u32 v24, v14, 7, v24
  s_lshl_b32 s54, s53, 14
  s_add_u32 s54, s54, 29696
  v_add_u32 v24, s54, v24
  buffer_load_dwordx4 v[64:67], v6, s[56:59], s51 offen nt
  s_add_u32 s51, s51, s52
  buffer_load_dwordx4 v[68:71], v6, s[56:59], s51 offen nt
  s_add_u32 s51, s51, s52
  buffer_load_dwordx4 v[72:75], v6, s[56:59], s51 offen nt
  s_add_u32 s51, s51, s52
  buffer_load_dwordx4 v[76:79], v6, s[56:59], s51 offen nt
  s_add_u32 s51, s51, s52
  buffer_load_dwordx4 v[80:83], v6, s[56:59], s51 offen nt
  s_add_u32 s51, s51, s52
  buffer_load_dwordx4 v[84:87], v6, s[56:59], s51 offen nt
  s_add_u32 s51, s51, s52
  buffer_load_dwordx4 v[88:91], v6, s[56:59], s51 offen nt
  s_add_u32 s51, s51, s52
  buffer_load_dwordx4 v[92:95], v6, s[56:59], s51 offen nt
  s_add_u32 s51, s51, s52
  buffer_load_dwordx4 v[96:99], v6, s[56:59], s40 offen nt
  s_add_u32 s40, s40, s52
  buffer_load_dwordx4 v[100:103], v6, s[56:59], s40 offen nt
  s_add_u32 s40, s40, s52
  buffer_load_dwordx4 v[104:107], v6, s[56:59], s40 offen nt
  s_add_u32 s40, s40, s52
  buffer_load_dwordx4 v[108:111], v6, s[56:59], s40 offen nt
  s_add_u32 s40, s40, s52
  buffer_load_dwordx4 v[112:115], v6, s[56:59], s40 offen nt
  s_add_u32 s40, s40, s52
  buffer_load_dwordx4 v[116:119], v6, s[56:59], s40 offen nt
  s_add_u32 s40, s40, s52
  buffer_load_dwordx4 v[120:123], v6, s[56:59], s40 offen nt
  s_add_u32 s40, s40, s52
  buffer_load_dwordx4 v[124:127], v6, s[56:59], s40 offen nt
  s_add_u32 s40, s40, s52
  s_waitcnt vmcnt(8)
  v_perm_b32 v32, v68, v64, s41
  v_perm_b32 v33, v76, v72, s41
  v_perm_b32 v34, v84, v80, s41
  v_perm_b32 v35, v92, v88, s41
  v_perm_b32 v36, v68, v64, s42
  v_perm_b32 v37, v76, v72, s42
  v_perm_b32 v38, v84, v80, s42
  v_perm_b32 v39, v92, v88, s42
  v_perm_b32 v40, v69, v65, s41
  v_perm_b32 v41, v77, v73, s41
  v_perm_b32 v42, v85, v81, s41
  v_perm_b32 v43, v93, v89, s41
  v_perm_b32 v44, v69, v65, s42
  v_perm_b32 v45, v77, v73, s42
  v_perm_b32 v46, v85, v81, s42
  v_perm_b32 v47, v93, v89, s42
  v_perm_b32 v48, v70, v66, s41
  v_perm_b32 v49, v78, v74, s41
  v_perm_b32 v50, v86, v82, s41
  v_perm_b32 v51, v94, v90, s41
  v_perm_b32 v52, v70, v66, s42
  v_perm_b32 v53, v78, v74, s42
  v_perm_b32 v54, v86, v82, s42
  v_perm_b32 v55, v94, v90, s42
  v_perm_b32 v56, v71, v67, s41
  v_perm_b32 v57, v79, v75, s41
  v_perm_b32 v58, v87, v83, s41
  v_perm_b32 v59, v95, v91, s41
  v_perm_b32 v60, v71, v67, s42
  v_perm_b32 v61, v79, v75, s42
  v_perm_b32 v62, v87, v83, s42
  v_perm_b32 v63, v95, v91, s42
  ds_write_b128 v24, v[32:35] offset:0
  ds_write_b128 v24, v[36:39] offset:16
  ds_write_b128 v24, v[40:43] offset:32
  ds_write_b128 v24, v[44:47] offset:48
  ds_write_b128 v24, v[48:51] offset:64
  ds_write_b128 v24, v[52:55] offset:80
  ds_write_b128 v24, v[56:59] offset:96
  ds_write_b128 v24, v[60:63] offset:112
  s_waitcnt lgkmcnt(0)
  s_waitcnt vmcnt(0)
  v_perm_b32 v32, v100, v96, s41
  v_perm_b32 v33, v108, v104, s41
  v_perm_b32 v34, v116, v112, s41
  v_perm_b32 v35, v124, v120, s41
  v_perm_b32 v36, v100, v96, s42
  v_perm_b32 v37, v108, v104, s42
  v_perm_b32 v38, v116, v112, s42
  v_perm_b32 v39, v124, v120, s42
  v_perm_b32 v40, v101, v97, s41
  v_perm_b32 v41, v109, v105, s41
  v_perm_b32 v42, v117, v113, s41
  v_perm_b32 v43, v125, v121, s41
  v_perm_b32 v44, v101, v97, s42
  v_perm_b32 v45, v109, v105, s42
  v_perm_b32 v46, v117, v113, s42
  v_perm_b32 v47, v125, v121, s42
  v_perm_b32 v48, v102, v98, s41
  v_perm_b32 v49, v110, v106, s41
  v_perm_b32 v50, v118, v114, s41
  v_perm_b32 v51, v126, v122, s41
  v_perm_b32 v52, v102, v98, s42
  v_perm_b32 v53, v110, v106, s42
  v_perm_b32 v54, v118, v114, s42
  v_perm_b32 v55, v126, v122, s42
  v_perm_b32 v56, v103, v99, s41
  v_perm_b32 v57, v111, v107, s41
  v_perm_b32 v58, v119, v115, s41
  v_perm_b32 v59, v127, v123, s41
  v_perm_b32 v60, v103, v99, s42
  v_perm_b32 v61, v111, v107, s42
  v_perm_b32 v62, v119, v115, s42
  v_perm_b32 v63, v127, v123, s42
  ds_write_b128 v24, v[32:35] offset:8192
  ds_write_b128 v24, v[36:39] offset:8208
  ds_write_b128 v24, v[40:43] offset:8224
  ds_write_b128 v24, v[44:47] offset:8240
  ds_write_b128 v24, v[48:51] offset:8256
  ds_write_b128 v24, v[52:55] offset:8272
  ds_write_b128 v24, v[56:59] offset:8288
  ds_write_b128 v24, v[60:63] offset:8304
  s_waitcnt lgkmcnt(0)
sequential_preLN__gqa_block_cached__glu_gated_bilinear__decode_kernel_C_pre:
  s_nop 1
  s_barrier
  s_nop 1
  v_and_b32 v5, 7, v2
  v_mul_u32_u24 v5, 3616, v5
  v_lshl_add_u32 v5, v3, 4, v5
  s_mul_i32 s50, s3, 448
  v_add_u32 v5, s50, v5
  s_mul_i32 s50, s3, 3584
  s_add_u32 s50, s50, 1146880
  v_lshlrev_b32 v18, 4, v1
  s_mul_i32 s51, s3, 3616
  v_add_u32 v19, s51, v18
  s_mul_i32 s51, s3, 14336
  s_add_u32 s51, s51, 29696
  v_lshl_add_u32 v7, v1, 4, s51
  ds_read_b128 v[64:67], v7 offset:0
  ds_read_b128 v[68:71], v7 offset:1024
  ds_read_b128 v[72:75], v7 offset:2048
  ds_read_b128 v[76:79], v7 offset:3072
  ds_read_b128 v[80:83], v7 offset:4096
  ds_read_b128 v[84:87], v7 offset:5120
  ds_read_b128 v[88:91], v7 offset:6144
  ds_read_b128 v[92:95], v7 offset:7168
  ds_read_b128 v[96:99], v7 offset:8192
  ds_read_b128 v[100:103], v7 offset:9216
  ds_read_b128 v[104:107], v7 offset:10240
  ds_read_b128 v[108:111], v7 offset:11264
  ds_read_b128 v[112:115], v7 offset:12288
  ds_read_b128 v[116:119], v7 offset:13312
  v_lshrrev_b32 v6, 5, v0
  v_and_b32 v6, 7, v6
  v_mul_u32_u24 v6, 896, v6
  v_and_b32 v9, 31, v0
  v_lshl_add_u32 v6, v9, 1, v6
  v_lshlrev_b32 v9, 1, v6
  s_lshl_b32 s53, s73, 6
  s_lshl_b32 s52, s73, 7
  s_add_u32 s52, s52, 1114112
  buffer_load_ushort v10, v6, s[28:31], s53 offen
  s_cmp_lg_u32 s3, 0
  s_cbranch_scc1 sequential_preLN__gqa_block_cached__glu_gated_bilinear__decode_kernel_CF_go
  s_and_b32 s51, s2, 7
  s_lshl_b32 s51, s51, 11
  s_add_u32 s51, s51, 1179648
  v_lshlrev_b32 v22, 7, v1
  v_min_u32 v22, 8064, v22
  v_lshlrev_b32 v22, 4, v1
  v_min_u32 v22, 880, v22
sequential_preLN__gqa_block_cached__glu_gated_bilinear__decode_kernel_CF_poll:
  buffer_load_dwordx4 v[32:35], v22, s[32:35], s51 offen sc1
  s_waitcnt vmcnt(0)
  v_xor_b32 v32, s62, v32
  v_xor_b32 v33, s63, v33
  v_xor_b32 v34, s62, v34
  v_xor_b32 v35, s63, v35
  v_or3_b32 v8, v32, v33, v34
  v_or_b32 v8, v8, v35
  v_cmp_ne_u32 vcc, 0, v8
  s_nop 1
  s_cbranch_vccz sequential_preLN__gqa_block_cached__glu_gated_bilinear__decode_kernel_CF_go
  s_cmp_eq_u32 s80, 0
  s_cbranch_scc1 sequential_preLN__gqa_block_cached__glu_gated_bilinear__decode_kernel_CF_go
  s_sub_u32 s80, s80, 1
  s_sleep 1
  s_branch sequential_preLN__gqa_block_cached__glu_gated_bilinear__decode_kernel_CF_poll
sequential_preLN__gqa_block_cached__glu_gated_bilinear__decode_kernel_CF_go:
  s_nop 1
  s_barrier
  buffer_load_dword v11, v9, s[32:35], s52 offen sc1
  v_mov_b32 v44, 0
  v_mov_b32 v45, 0
  v_mov_b32 v46, 0
  v_mov_b32 v47, 0
  s_cmp_lg_u32 s3, 0
  s_cbranch_scc1 sequential_preLN__gqa_block_cached__glu_gated_bilinear__decode_kernel_C3_go
  s_mov_b32 s51, 1081344
  v_lshlrev_b32 v22, 7, v1
  v_min_u32 v22, 3456, v22
sequential_preLN__gqa_block_cached__glu_gated_bilinear__decode_kernel_C3_poll:
  buffer_load_dwordx2 v[32:33], v22, s[32:35], s51 offen sc1
  s_waitcnt vmcnt(0)
  v_xor_b32 v32, s62, v32
  v_xor_b32 v33, s63, v33
  v_or_b32 v8, v32, v33
  v_cmp_ne_u32 vcc, 0, v8
  s_nop 1
  s_cbranch_vccz sequential_preLN__gqa_block_cached__glu_gated_bilinear__decode_kernel_C3_go
  s_cmp_eq_u32 s80, 0
  s_cbranch_scc1 sequential_preLN__gqa_block_cached__glu_gated_bilinear__decode_kernel_C3_go
  s_sub_u32 s80, s80, 1
  s_sleep 1
  s_branch sequential_preLN__gqa_block_cached__glu_gated_bilinear__decode_kernel_C3_poll
sequential_preLN__gqa_block_cached__glu_gated_bilinear__decode_kernel_C3_go:
  s_nop 1
  s_barrier
sequential_preLN__gqa_block_cached__glu_gated_bilinear__decode_kernel_C_ld:
  buffer_load_dwordx4 v[32:35], v18, s[32:35], s50 offen offset:0 sc1
  buffer_load_dwordx4 v[36:39], v18, s[32:35], s50 offen offset:1024 sc1
  buffer_load_dwordx4 v[40:43], v18, s[32:35], s50 offen offset:2048 sc1
  s_mov_b32 exec_hi, 0
  buffer_load_dwordx4 v[44:47], v18, s[32:35], s50 offen offset:3072 sc1
  s_mov_b64 exec, -1
  s_waitcnt vmcnt(0)
  v_max3_u32 v8, v32, v33, v34
  v_max3_u32 v8, v8, v35, v36
  v_max3_u32 v8, v8, v37, v38
  v_max3_u32 v8, v8, v39, v40
  v_max3_u32 v8, v8, v41, v42
  v_max3_u32 v8, v8, v43, v44
  v_max3_u32 v8, v8, v45, v46
  v_max_u32 v8, v8, v47
  v_cmp_eq_u32 vcc, -1, v8
  s_nop 1
  s_cbranch_vccz sequential_preLN__gqa_block_cached__glu_gated_bilinear__decode_kernel_C_ok
  s_cmp_eq_u32 s80, 0
  s_cbranch_scc1 sequential_preLN__gqa_block_cached__glu_gated_bilinear__decode_kernel_C_ok
  s_sub_u32 s80, s80, 1
  s_sleep 1
  s_branch sequential_preLN__gqa_block_cached__glu_gated_bilinear__decode_kernel_C_ld
sequential_preLN__gqa_block_cached__glu_gated_bilinear__decode_kernel_C_ok:
  ds_write_b128 v19, v[32:35] offset:0
  ds_write_b128 v19, v[36:39] offset:1024
  ds_write_b128 v19, v[40:43] offset:2048
  s_mov_b32 exec_hi, 0
  ds_write_b128 v19, v[44:47] offset:3072
  s_mov_b64 exec, -1
  s_waitcnt lgkmcnt(0)
  s_barrier
  ds_read_b128 v[32:35], v5 offset:0
  ds_read_b128 v[36:39], v5 offset:64
  ds_read_b128 v[40:43], v5 offset:128
  ds_read_b128 v[44:47], v5 offset:192
  ds_read_b128 v[48:51], v5 offset:256
  ds_read_b128 v[52:55], v5 offset:320
  ds_read_b128 v[56:59], v5 offset:384
  s_waitcnt lgkmcnt(0)
  v_mfma_f32_16x16x32_bf16 v[20:23], v[32:35], v[64:67], 0
  v_mfma_f32_16x16x32_bf16 v[24:27], v[32:35], v[68:71], 0
  v_mfma_f32_16x16x32_bf16 v[20:23], v[36:39], v[72:75], v[20:23]
  v_mfma_f32_16x16x32_bf16 v[24:27], v[36:39], v[76:79], v[24:27]
  v_mfma_f32_16x16x32_bf16 v[20:23], v[40:43], v[80:83], v[20:23]
  v_mfma_f32_16x16x32_bf16 v[24:27], v[40:43], v[84:87], v[24:27]
  v_mfma_f32_16x16x32_bf16 v[20:23], v[44:47], v[88:91], v[20:23]
  v_mfma_f32_16x16x32_bf16 v[24:27], v[44:47], v[92:95], v[24:27]
  v_mfma_f32_16x16x32_bf16 v[20:23], v[48:51], v[96:99], v[20:23]
  v_mfma_f32_16x16x32_bf16 v[24:27], v[48:51], v[100:103], v[24:27]
  v_mfma_f32_16x16x32_bf16 v[20:23], v[52:55], v[104:107], v[20:23]
  v_mfma_f32_16x16x32_bf16 v[24:27], v[52:55], v[108:111], v[24:27]
  v_mfma_f32_16x16x32_bf16 v[20:23], v[56:59], v[112:115], v[20:23]
  v_mfma_f32_16x16x32_bf16 v[24:27], v[56:59], v[116:119], v[24:27]
  v_and_b32 v5, 1, v3
  v_lshlrev_b32 v5, 9, v5
  v_lshl_add_u32 v5, v2, 2, v5
  s_lshl_b32 s51, s3, 10
  s_add_u32 s51, s51, 144384
  v_add_u32 v5, s51, v5
  v_cvt_pk_bf16_f32 v11, v11, v11
  v_lshlrev_b32 v11, 16, v11
  v_lshlrev_b32 v10, 16, v10
  v_add_f32 v10, v10, v11
  v_cvt_pk_bf16_f32 v10, v10, v10
  v_lshlrev_b32 v10, 16, v10
  ds_write_b32 v5, v20 offset:0
  ds_write_b32 v5, v21 offset:128
  ds_write_b32 v5, v22 offset:256
  ds_write_b32 v5, v23 offset:384
  ds_write_b32 v5, v24 offset:64
  ds_write_b32 v5, v25 offset:192
  ds_write_b32 v5, v26 offset:320
  ds_write_b32 v5, v27 offset:448
  s_waitcnt lgkmcnt(0)
  s_cmp_eq_u32 s85, 1
  s_cbranch_scc1 sequential_preLN__gqa_block_cached__glu_gated_bilinear__decode_kernel_nb7
  s_barrier
sequential_preLN__gqa_block_cached__glu_gated_bilinear__decode_kernel_nb7:
  s_cmp_ge_u32 s3, 4
  s_cbranch_scc1 sequential_preLN__gqa_block_cached__glu_gated_bilinear__decode_kernel_done
  v_lshlrev_b32 v5, 2, v0
  v_add_u32 v5, 144384, v5
  ds_read_b32 v16, v5 offset:0
  ds_read_b32 v17, v5 offset:1024
  ds_read_b32 v18, v5 offset:2048
  ds_read_b32 v19, v5 offset:3072
  ds_read_b32 v20, v5 offset:4096
  ds_read_b32 v21, v5 offset:5120
  ds_read_b32 v22, v5 offset:6144
  ds_read_b32 v23, v5 offset:7168
  s_mov_b32 s56, s70
  s_mov_b32 s57, s71
  s_min_u32 s58, s26, 7168
  s_mov_b32 s59, 0x00020000
  s_waitcnt lgkmcnt(0)
  v_add_f32 v16, v16, v17
  v_add_f32 v18, v18, v19
  v_add_f32 v20, v20, v21
  v_add_f32 v22, v22, v23
  v_add_f32 v16, v16, v18
  v_add_f32 v20, v20, v22
  v_add_f32 v16, v16, v20
  v_cvt_pk_bf16_f32 v16, v16, v16
  v_lshlrev_b32 v16, 16, v16
  v_add_f32 v10, v10, v16
  v_cvt_pk_bf16_f32 v10, v10, v10
  buffer_store_short v10, v6, s[56:59], s53 offen
  s_cmp_lg_u32 s73, 0
  s_cbranch_scc1 sequential_preLN__gqa_block_cached__glu_gated_bilinear__decode_kernel_noep
  s_cmp_lg_u32 s3, 0
  s_cbranch_scc1 sequential_preLN__gqa_block_cached__glu_gated_bilinear__decode_kernel_noep
  v_mov_b32 v12, s62
  v_mov_b32 v13, s63
  v_mov_b32 v14, 0
  s_mov_b32 s51, 1277952
  s_mov_b64 exec, 1
  buffer_store_dwordx2 v[12:13], v14, s[24:27], s51 offen sc1
  s_mov_b64 exec, -1
sequential_preLN__gqa_block_cached__glu_gated_bilinear__decode_kernel_noep:
sequential_preLN__gqa_block_cached__glu_gated_bilinear__decode_kernel_done:
  s_cmp_eq_u32 s85, 1
  s_cbranch_scc1 sequential_preLN__gqa_block_cached__glu_gated_bilinear__decode_kernel_dryret
sequential_preLN__gqa_block_cached__glu_gated_bilinear__decode_kernel_exit:
  s_endpgm
.section .rodata,"a"
.p2align 6
.amdhsa_kernel sequential_preLN__gqa_block_cached__glu_gated_bilinear__decode_kernel
  .amdhsa_next_free_vgpr 256
  .amdhsa_next_free_sgpr 102
  .amdhsa_accum_offset 256
  .amdhsa_group_segment_fixed_size 0
  .amdhsa_kernarg_size 96
  .amdhsa_user_sgpr_count 2
  .amdhsa_user_sgpr_kernarg_segment_ptr 1
  .amdhsa_system_sgpr_workgroup_id_x 1
.end_amdhsa_kernel
```
